```python
import torch

def _softmax(x, axis=-1):
    return torch.softmax(x, dim=axis)
def _gelu(x):
    return torch.nn.functional.gelu(x, approximate="tanh")
def _silu(x):
    return torch.nn.functional.silu(x)
def _sigmoid(x):
    return torch.sigmoid(x)
def _layernorm(x, axis=-1, eps=1e-5):
    m = x.mean(dim=axis, keepdim=True)
    v = x.var(dim=axis, keepdim=True, unbiased=False)
    return (x - m) / torch.sqrt(v + eps)
def _scatter_add(tgt, idx, src, axis=0):
    return tgt.clone().index_add_(axis, idx, src)
def _segment_sum(src, seg, n):
    out = torch.zeros((n,) + src.shape[1:], dtype=src.dtype)
    return out.index_add_(0, seg, src)
def _pad(x, pw):
    flat = tuple(v for pair in reversed(pw) for v in pair)
    return torch.nn.functional.pad(x, flat)

kernel_name = 'concat_heads__gqa_block_cached__gqa_block_cached__decode'

def setup_inputs():

    _w = (lambda a: (lambda t: t.to(torch.bfloat16) if t.is_floating_point() else t)(torch.as_tensor(a)))
    def _A_setup():
        B, Sq, D = 8, 1, 448
        Hq, Hkv, Sk, Dh = 16, 8, 4096, 256
        assert Hq % Hkv == 0, (Hq, Hkv)
        return {
            "x": _w((lambda *s: torch.randn(*s, dtype=torch.bfloat16) * 0.8)(B, Sq, D)),
            "k_cache": _w((lambda *s: torch.randn(*s, dtype=torch.bfloat16) * 0.8)(B, Hkv, Sk, Dh)),
            "v_cache": _w((lambda *s: torch.randn(*s, dtype=torch.bfloat16) * 0.05)(B, Hkv, Sk, Dh)),
            "wq": _w((lambda *s: torch.randn(*s, dtype=torch.bfloat16) * 0.8)(D, Hq * Dh) * (D ** -0.5)),
            "wo": _w((lambda *s: torch.randn(*s, dtype=torch.bfloat16) * 0.05)(Hq * Dh, D) * ((Hq * Dh) ** -0.5)),
        }
    _A_in = _A_setup()

    def _B_setup():
        B, Sq, D = 8, 1, 448
        Hq, Hkv, Sk, Dh = 16, 8, 4096, 256
        assert Hq % Hkv == 0, (Hq, Hkv)
        return {
            "x": _w((lambda *s: torch.randn(*s, dtype=torch.bfloat16) * 0.8)(B, Sq, D)),
            "k_cache": _w((lambda *s: torch.randn(*s, dtype=torch.bfloat16) * 0.8)(B, Hkv, Sk, Dh)),
            "v_cache": _w((lambda *s: torch.randn(*s, dtype=torch.bfloat16) * 0.05)(B, Hkv, Sk, Dh)),
            "wq": _w((lambda *s: torch.randn(*s, dtype=torch.bfloat16) * 0.8)(D, Hq * Dh) * (D ** -0.5)),
            "wo": _w((lambda *s: torch.randn(*s, dtype=torch.bfloat16) * 0.05)(Hq * Dh, D) * ((Hq * Dh) ** -0.5)),
        }
    _B_in = _B_setup()

    return {
        "A_x": _A_in["x"],
        "A_k_cache": _A_in["k_cache"],
        "A_v_cache": _A_in["v_cache"],
        "A_wq": _A_in["wq"],
        "A_wo": _A_in["wo"],
        "B_x": _B_in["x"],
        "B_k_cache": _B_in["k_cache"],
        "B_v_cache": _B_in["v_cache"],
        "B_wq": _B_in["wq"],
        "B_wo": _B_in["wo"],
    }

def reference(A_x, A_k_cache, A_v_cache, A_wq, A_wo, B_x, B_k_cache, B_v_cache, B_wq, B_wo):
    def _A_ref(x, k_cache, v_cache, wq, wo):
        B, Sq, D = x.shape
        Hq, Dh = 16, 256
        Hkv = k_cache.shape[1]
        rep = Hq // Hkv
        q = (lambda x, *d: x.permute(*d))((x @ wq).reshape(B, Sq, Hq, Dh), 0, 2, 1, 3)
        k = (lambda x, n, axis: torch.repeat_interleave(x, n, dim=axis))(k_cache, rep, axis=1)
        v = (lambda x, n, axis: torch.repeat_interleave(x, n, dim=axis))(v_cache, rep, axis=1)
        scores = torch.einsum("bhqd,bhkd->bhqk", q, k) * (Dh ** -0.5)
        p = _softmax(scores, axis=-1)
        o = torch.einsum("bhqk,bhkd->bhqd", p, v)
        return (lambda x, *d: x.permute(*d))(o, 0, 2, 1, 3).reshape(B, Sq, Hq * Dh) @ wo

    def _B_ref(x, k_cache, v_cache, wq, wo):
        B, Sq, D = x.shape
        Hq, Dh = 16, 256
        Hkv = k_cache.shape[1]
        rep = Hq // Hkv
        q = (lambda x, *d: x.permute(*d))((x @ wq).reshape(B, Sq, Hq, Dh), 0, 2, 1, 3)
        k = (lambda x, n, axis: torch.repeat_interleave(x, n, dim=axis))(k_cache, rep, axis=1)
        v = (lambda x, n, axis: torch.repeat_interleave(x, n, dim=axis))(v_cache, rep, axis=1)
        scores = torch.einsum("bhqd,bhkd->bhqk", q, k) * (Dh ** -0.5)
        p = _softmax(scores, axis=-1)
        o = torch.einsum("bhqk,bhkd->bhqd", p, v)
        return (lambda x, *d: x.permute(*d))(o, 0, 2, 1, 3).reshape(B, Sq, Hq * Dh) @ wo

    a = _A_ref(A_x, A_k_cache, A_v_cache, A_wq, A_wo)
    b = _B_ref(B_x, B_k_cache, B_v_cache, B_wq, B_wo)
    return torch.concatenate([a, b], axis=-1)
```

```asm
; @launch grid=(256,1,1) block=(512,1,1) lds=163328
.amdgcn_target "amdgcn-amd-amdhsa--gfx950"
.text
.globl concat_heads__gqa_block_cached__gqa_block_cached__decode_kernel
.p2align 8
.type concat_heads__gqa_block_cached__gqa_block_cached__decode_kernel,@function
concat_heads__gqa_block_cached__gqa_block_cached__decode_kernel:
    s_load_dwordx4 s[12:15], s[0:1], 8
    s_load_dwordx2 s[24:25], s[0:1], 96
    s_cmpk_ge_u32 s2, 256
    s_cbranch_scc1 L_done
    s_lshr_b32 s6, s2, 7
    s_mul_i32 s3, s6, 40
    s_add_u32 s18, s0, s3
    s_addc_u32 s19, s1, 0
    s_load_dwordx2 s[10:11], s[18:19], 24
    s_load_dwordx2 s[8:9], s[18:19], 0
    v_readfirstlane_b32 s7, v0
    s_and_b32 s4, s2, 7
    s_lshr_b32 s5, s2, 3
    s_lshr_b32 s7, s7, 6
    s_sub_u32 s36, s7, 1
    s_cmp_gt_u32 s36, 2
    s_cbranch_scc1 L_other
    v_bfe_u32 v5, v0, 2, 4
    v_and_b32 v6, 3, v0
    v_lshlrev_b32 v5, 13, v5
    v_lshl_add_u32 v5, v6, 4, v5
    s_mov_b32 s31, 0x20000
    s_mul_i32 s36, s36, 5
    s_lshl_b32 s37, s36, 11
    s_add_u32 m0, s37, s31
    s_and_b32 s46, s5, 15
    s_lshl_b32 s3, s4, 4
    s_add_u32 s3, s3, s46
    s_lshl_b32 s3, s3, 6
    s_lshl_b32 s38, s36, 18
    s_sub_u32 s30, 3670016, s3
    s_mov_b32 s40, 4
    s_and_b32 s41, s2, 63
    s_lshl_b32 s41, s41, 21
    v_mov_b32 v7, s41
    s_waitcnt lgkmcnt(0)
    s_add_u32 s28, s10, s3
    s_addc_u32 s29, s11, 0
    s_and_b32 s29, s29, 0xffff
    s_load_dword s26, s[24:25], 0
    global_load_dword v255, v7, s[12:13] nt
L_ql:
    buffer_load_dwordx4 v5, s[28:31], s38 offen nt lds
    s_addk_i32 m0, 0x400
    s_add_u32 s38, s38, s31
    buffer_load_dwordx4 v5, s[28:31], s38 offen nt lds
    s_addk_i32 m0, 0x400
    s_add_u32 s38, s38, s31
    s_sub_u32 s40, s40, 1
    s_cbranch_scc0 L_ql
    s_barrier
    s_branch L_qc
L_other:
    v_and_b32 v0, 63, v0
    v_mov_b32 v2, 161792
    s_mov_b32 s27, 0x1000000
    s_cmp_lg_u32 s7, 0
    s_cbranch_scc1 L_rest
L_loader:
    s_setprio 3
    v_lshrrev_b32 v3, 5, v0
    v_and_b32 v4, 31, v0
    v_lshlrev_b32 v5, 12, v3
    v_xor_b32 v6, v4, v3
    v_xor_b32 v7, 0, v6
    v_lshl_add_u32 v7, v7, 4, v5
    v_add_u32 v48, 3072, v7
    v_add_u32 v56, 4096, v7
    v_xor_b32 v7, 2, v6
    v_lshl_add_u32 v7, v7, 4, v5
    v_add_u32 v49, 4096, v7
    v_add_u32 v57, 5120, v7
    v_xor_b32 v7, 4, v6
    v_lshl_add_u32 v7, v7, 4, v5
    v_add_u32 v50, 1536, v7
    v_add_u32 v58, 2560, v7
    v_xor_b32 v7, 6, v6
    v_lshl_add_u32 v7, v7, 4, v5
    v_add_u32 v51, 2560, v7
    v_add_u32 v59, 3584, v7
    v_xor_b32 v7, 8, v6
    v_lshl_add_u32 v7, v7, 4, v5
    v_add_u32 v52, 11264, v7
    v_add_u32 v60, 12288, v7
    v_xor_b32 v7, 10, v6
    v_lshl_add_u32 v7, v7, 4, v5
    v_add_u32 v53, 12288, v7
    v_add_u32 v61, 13312, v7
    v_xor_b32 v7, 12, v6
    v_lshl_add_u32 v7, v7, 4, v5
    v_add_u32 v54, 9728, v7
    v_add_u32 v62, 10752, v7
    v_xor_b32 v7, 14, v6
    v_lshl_add_u32 v7, v7, 4, v5
    v_add_u32 v55, 10752, v7
    v_add_u32 v63, 11776, v7
    s_and_b32 s49, s2, 63
    s_lshl_b32 s49, s49, 21
    s_bfe_u32 s67, s5, 0x10003
    s_lshl_b32 s67, s67, 16
    s_lshl_b32 s3, s6, 14
    s_or_b32 s67, s67, s3
    s_mov_b32 s30, 2100224
    s_mov_b32 s31, 0x20000
    s_mov_b32 m0, 0
    s_waitcnt lgkmcnt(0)
    s_add_u32 s28, s12, s49
    s_addc_u32 s29, s13, 0
    s_sub_u32 s28, s28, 3072
    s_subb_u32 s29, s29, 0
    s_and_b32 s29, s29, 0xffff
    s_barrier
    buffer_load_dwordx4 v48, s[28:31], s67 offen offset:0 nt lds
    buffer_load_dwordx4 v49, s[28:31], s67 offen offset:1024 nt lds
    buffer_load_dwordx4 v50, s[28:31], s67 offen offset:2048 nt lds
    buffer_load_dwordx4 v51, s[28:31], s67 offen offset:3072 nt lds
    s_add_u32 m0, m0, 0x1000
    s_nop 0
    buffer_load_dwordx4 v52, s[28:31], s67 offen offset:0 nt lds
    buffer_load_dwordx4 v53, s[28:31], s67 offen offset:1024 nt lds
    buffer_load_dwordx4 v54, s[28:31], s67 offen offset:2048 nt lds
    buffer_load_dwordx4 v55, s[28:31], s67 offen offset:3072 nt lds
    s_add_u32 m0, m0, 0x1000
    s_nop 0
    buffer_load_dwordx4 v56, s[28:31], s67 offen offset:0 nt lds
    buffer_load_dwordx4 v57, s[28:31], s67 offen offset:1024 nt lds
    buffer_load_dwordx4 v58, s[28:31], s67 offen offset:2048 nt lds
    buffer_load_dwordx4 v59, s[28:31], s67 offen offset:3072 nt lds
    s_add_u32 m0, m0, 0x1000
    s_nop 0
    buffer_load_dwordx4 v60, s[28:31], s67 offen offset:0 nt lds
    buffer_load_dwordx4 v61, s[28:31], s67 offen offset:1024 nt lds
    buffer_load_dwordx4 v62, s[28:31], s67 offen offset:2048 nt lds
    buffer_load_dwordx4 v63, s[28:31], s67 offen offset:3072 nt lds
    s_add_u32 m0, m0, 0x1000
    s_nop 0
    s_branch L_ld2
L_rest:
    s_getpc_b64 s[22:23]
L_pc:
    s_and_b32 s3, s2, 0xf8
    v_and_or_b32 v254, v0, 7, s3
    v_lshlrev_b32 v254, 6, v254
    v_min_u32 v254, L_done-L_pc, v254
    s_mov_b64 exec, 0xff
    global_load_dword v255, v254, s[22:23]
    s_mov_b64 exec, -1
    v_lshl_add_u32 v5, v0, 2, v2
    v_mov_b32 v4, 0
    ds_write_b32 v5, v4
    s_cmp_lg_u32 s7, 4
    s_cbranch_scc1 L_rest2
    s_lshl_b32 s3, s4, 16
    s_lshl_b32 s41, s5, 9
    s_add_u32 s3, s3, s41
    s_add_u32 s3, s3, 524288
    v_bfe_u32 v5, v0, 3, 2
    v_lshlrev_b32 v5, 14, v5
    v_and_b32 v6, 7, v0
    v_lshl_add_u32 v5, v6, 6, v5
    v_add_u32 v5, s3, v5
    v_and_b32 v7, 1, v0
    v_lshlrev_b32 v7, 6, v7
    v_bfe_u32 v6, v0, 1, 3
    s_lshl_b32 s3, s4, 15
    s_lshl_b32 s41, s5, 7
    s_add_u32 s3, s3, s41
    s_add_u32 s3, s3, 4096
    s_mov_b32 exec_lo, 0
    v_lshl_add_u32 v5, v6, 12, v7
    v_add_u32 v5, s3, v5
    s_lshl_b32 s3, s4, 3
    s_and_b32 s41, s5, 7
    s_add_u32 s3, s3, s41
    s_lshl_b32 s3, s3, 7
    s_add_u32 s3, s3, 327680
    s_mov_b32 exec_hi, 0xf0000
    v_lshl_add_u32 v5, v6, 13, v7
    v_add_u32 v5, s3, v5
    s_mov_b32 exec_lo, -1
    s_mov_b32 exec_hi, 0xfffff
    s_waitcnt lgkmcnt(0)
    global_load_dword v255, v5, s[24:25] sc1
    s_mov_b64 exec, -1
L_rest2:
    s_waitcnt lgkmcnt(0)
    s_barrier
    s_cmp_eq_u32 s7, 6
    s_cbranch_scc1 L_ctl
    s_cmp_eq_u32 s7, 7
    s_cbranch_scc1 L_pv0
    s_branch L_tail0
L_qc:
    s_add_u32 s37, s37, s31
    v_and_b32 v0, 63, v0
    v_mov_b32 v2, 161792
    s_mov_b32 s27, 0x1000000
    v_and_b32 v3, 15, v0
    v_lshrrev_b32 v4, 4, v0
    v_and_b32 v7, 7, v0
    v_mul_u32_u24 v7, 896, v7
    v_lshl_add_u32 v7, v4, 4, v7
    s_mov_b32 s32, s8
    s_and_b32 s33, s9, 0xffff
    s_mov_b32 s34, 7168
    s_mov_b32 s35, 0x20000
    s_lshl_b32 s39, s36, 6
    s_mov_b32 exec_lo, 0x00ff00ff
    s_mov_b32 exec_hi, 0x00ff00ff
    buffer_load_dwordx4 v[12:15], v7, s[32:35], s39 offen offset:0
    buffer_load_dwordx4 v[16:19], v7, s[32:35], s39 offen offset:64
    buffer_load_dwordx4 v[20:23], v7, s[32:35], s39 offen offset:128
    buffer_load_dwordx4 v[24:27], v7, s[32:35], s39 offen offset:192
    buffer_load_dwordx4 v[28:31], v7, s[32:35], s39 offen offset:256
    s_mov_b64 exec, -1
    v_lshrrev_b32 v8, 2, v3
    v_lshl_add_u32 v8, v4, 3, v8
    v_lshlrev_b32 v8, 6, v8
    v_lshl_add_u32 v8, v6, 3, v8
    v_add_u32 v8, s37, v8
    v_lshlrev_b32 v9, 5, v0
    v_add_u32 v10, s37, v9
    s_getreg_b32 s51, hwreg(HW_REG_XCC_ID, 0, 3)
    s_waitcnt vmcnt(0)
    ds_read_b64_tr_b16 v[32:33], v8 offset:0
    ds_read_b64_tr_b16 v[34:35], v8 offset:256
    ds_read_b64_tr_b16 v[36:37], v8 offset:32
    ds_read_b64_tr_b16 v[38:39], v8 offset:288
    ds_read_b64_tr_b16 v[40:41], v8 offset:2048
    ds_read_b64_tr_b16 v[42:43], v8 offset:2304
    ds_read_b64_tr_b16 v[44:45], v8 offset:2080
    ds_read_b64_tr_b16 v[46:47], v8 offset:2336
    ds_read_b64_tr_b16 v[48:49], v8 offset:4096
    ds_read_b64_tr_b16 v[50:51], v8 offset:4352
    ds_read_b64_tr_b16 v[52:53], v8 offset:4128
    ds_read_b64_tr_b16 v[54:55], v8 offset:4384
    ds_read_b64_tr_b16 v[56:57], v8 offset:6144
    ds_read_b64_tr_b16 v[58:59], v8 offset:6400
    ds_read_b64_tr_b16 v[60:61], v8 offset:6176
    ds_read_b64_tr_b16 v[62:63], v8 offset:6432
    ds_read_b64_tr_b16 v[64:65], v8 offset:8192
    ds_read_b64_tr_b16 v[66:67], v8 offset:8448
    ds_read_b64_tr_b16 v[68:69], v8 offset:8224
    ds_read_b64_tr_b16 v[70:71], v8 offset:8480
    s_waitcnt lgkmcnt(0)
    v_mfma_f32_16x16x32_bf16 v[72:75], v[32:35], v[12:15], 0
    v_mfma_f32_16x16x32_bf16 v[76:79], v[36:39], v[12:15], 0
    v_mfma_f32_16x16x32_bf16 v[72:75], v[40:43], v[16:19], v[72:75]
    v_mfma_f32_16x16x32_bf16 v[76:79], v[44:47], v[16:19], v[76:79]
    v_mfma_f32_16x16x32_bf16 v[72:75], v[48:51], v[20:23], v[72:75]
    v_mfma_f32_16x16x32_bf16 v[76:79], v[52:55], v[20:23], v[76:79]
    v_mfma_f32_16x16x32_bf16 v[72:75], v[56:59], v[24:27], v[72:75]
    v_mfma_f32_16x16x32_bf16 v[76:79], v[60:63], v[24:27], v[76:79]
    s_cmp_eq_u32 s7, 3
    s_cbranch_scc1 L_q4b
    v_mfma_f32_16x16x32_bf16 v[72:75], v[64:67], v[28:31], v[72:75]
    v_mfma_f32_16x16x32_bf16 v[76:79], v[68:71], v[28:31], v[76:79]
L_q4b:
    s_add_u32 s26, s26, 1
    v_mov_b32 v11, 1
    v_mov_b32 v12, s26
    s_and_b32 s45, s26, 0x1fffffff
    s_lshl_b32 s51, s51, 29
    s_or_b32 s45, s45, s51
    s_nop 3
    ds_write_b128 v10, v[72:75]
    ds_write_b128 v10, v[76:79] offset:16
    s_mov_b64 exec, 1
    ds_write_b32 v2, v12 offset:28
    s_waitcnt lgkmcnt(0)
    ds_add_rtn_u32 v11, v2, v11 offset:44
    s_mov_b64 exec, -1
    v_lshrrev_b32 v13, 3, v0
    v_lshl_add_u32 v9, v6, 4, v13
    v_lshlrev_b32 v9, 5, v9
    v_and_b32 v14, 4, v0
    v_lshl_add_u32 v9, v14, 2, v9
    v_add_u32 v9, 131072, v9
    s_lshl_b32 s3, s4, 15
    s_lshl_b32 s41, s5, 7
    s_add_u32 s3, s3, s41
    s_add_u32 s3, s3, 4096
    v_and_b32 v224, 7, v0
    v_lshlrev_b32 v224, 4, v224
    v_lshl_add_u32 v224, v13, 12, v224
    v_add_u32 v224, s3, v224
    v_lshlrev_b32 v36, 3, v0
    v_add_u32 v36, 159744, v36
    s_waitcnt lgkmcnt(0)
    v_readfirstlane_b32 s41, v11
    s_cmp_lg_u32 s41, 2
    s_cbranch_scc1 L_qdone
    ds_read_b128 v[16:19], v9
    ds_read_b128 v[20:23], v9 offset:10240
    ds_read_b128 v[28:31], v9 offset:20480
    v_mov_b32 v25, s45
    v_mov_b32 v27, s45
    v_mov_b32 v11, 1
    s_waitcnt lgkmcnt(0)
    v_add_f32 v16, v16, v20
    v_add_f32 v17, v17, v21
    v_add_f32 v18, v18, v22
    v_add_f32 v19, v19, v23
    v_add_f32 v16, v16, v28
    v_add_f32 v17, v17, v29
    v_add_f32 v18, v18, v30
    v_add_f32 v19, v19, v31
    v_cvt_pk_bf16_f32 v24, v16, v17
    v_cvt_pk_bf16_f32 v26, v18, v19
    ds_write2_b32 v36, v24, v26 offset1:1
    s_mov_b64 exec, 1
    ds_add_u32 v2, v11 offset:44
    s_mov_b64 exec, -1
    s_waitcnt lgkmcnt(0)
    global_store_dwordx4 v224, v[24:27], s[24:25]
L_qdone:
    s_cmp_lg_u32 s7, 1
    s_cbranch_scc1 L_tail
    s_branch L_comp
L_ld2:
    s_load_dwordx4 s[16:19], s[0:1], 48
    s_load_dwordx2 s[8:9], s[0:1], 32
    s_load_dwordx2 s[20:21], s[0:1], 72
    v_lshlrev_b32 v6, 1, v3
    v_xor_b32 v6, v4, v6
    v_xor_b32 v7, 0, v6
    v_lshl_add_u32 v7, v7, 4, v5
    v_add_u32 v64, 3072, v7
    v_add_u32 v68, 11264, v7
    v_add_u32 v72, 4096, v7
    v_add_u32 v76, 12288, v7
    v_xor_b32 v7, 4, v6
    v_lshl_add_u32 v7, v7, 4, v5
    v_add_u32 v65, 4096, v7
    v_add_u32 v69, 12288, v7
    v_add_u32 v73, 5120, v7
    v_add_u32 v77, 13312, v7
    v_xor_b32 v7, 8, v6
    v_lshl_add_u32 v7, v7, 4, v5
    v_add_u32 v66, 1536, v7
    v_add_u32 v70, 9728, v7
    v_add_u32 v74, 2560, v7
    v_add_u32 v78, 10752, v7
    v_xor_b32 v7, 12, v6
    v_lshl_add_u32 v7, v7, 4, v5
    v_add_u32 v67, 2560, v7
    v_add_u32 v71, 10752, v7
    v_add_u32 v75, 3584, v7
    v_add_u32 v79, 11776, v7
    v_mov_b32 v8, s67
    v_bfe_u32 v7, v0, 0, 1
    v_lshl_or_b32 v8, v7, 19, v8
    v_bfe_u32 v7, v0, 1, 1
    v_lshl_or_b32 v8, v7, 17, v8
    v_bfe_u32 v7, v0, 2, 1
    v_lshl_or_b32 v8, v7, 15, v8
    v_bfe_u32 v7, v0, 3, 1
    v_lshl_or_b32 v8, v7, 18, v8
    v_bfe_u32 v7, v0, 4, 1
    v_lshl_or_b32 v8, v7, 20, v8
    s_lshl_b32 s3, s4, 1
    s_bfe_u32 s39, s5, 0x10001
    s_add_u32 s3, s3, s39
    s_lshl_b32 s3, s3, 8
    s_and_b32 s39, s5, 1
    s_lshl_b32 s39, s39, 6
    s_add_u32 s3, s3, s39
    s_mul_i32 s3, s3, 896
    s_lshr_b32 s39, s5, 2
    s_min_u32 s39, s39, 6
    s_lshl_b32 s39, s39, 7
    s_add_u32 s68, s3, s39
    v_lshrrev_b32 v6, 3, v0
    v_bfe_u32 v7, v0, 4, 1
    v_xor_b32 v6, v6, v7
    v_mul_u32_u24 v6, 896, v6
    v_and_b32 v7, 7, v0
    v_xor_b32 v7, 0, v7
    v_lshl_add_u32 v26, v7, 4, v6
    v_add_u32 v26, 3072, v26
    v_and_b32 v7, 7, v0
    v_xor_b32 v7, 2, v7
    v_lshl_add_u32 v27, v7, 4, v6
    v_add_u32 v27, 16384, v27
    v_and_b32 v7, 7, v0
    v_xor_b32 v7, 4, v7
    v_lshl_add_u32 v28, v7, 4, v6
    v_add_u32 v28, 115712, v28
    v_and_b32 v7, 7, v0
    v_xor_b32 v7, 6, v7
    v_lshl_add_u32 v29, v7, 4, v6
    v_add_u32 v29, 129024, v29
    s_sub_u32 s54, 3673088, s68
    s_mov_b32 s55, 0x20000
    s_cmp_ge_u32 s5, 28
    s_cselect_b32 s54, 0, s54
    s_mov_b32 s66, 143360
    s_mov_b32 s37, 1
    s_mov_b32 s70, 32
    s_mov_b32 s71, 18
    s_and_b32 s3, s5, 14
    s_cmp_eq_u32 s3, 6
    s_cselect_b32 s71, 22, s71
    s_mov_b32 s44, s71
    v_readlane_b32 s41, v8, 1
    s_waitcnt lgkmcnt(0)
    s_add_u32 s52, s8, s68
    s_addc_u32 s53, s9, 0
    s_sub_u32 s52, s52, 3072
    s_subb_u32 s53, s53, 0
    s_and_b32 s53, s53, 0xffff
    s_branch L_pick
L_common:
    s_and_b32 m0, m0, 0x1ffff
    s_sub_u32 s39, s37, 1
    v_mov_b32 v21, s37
    v_mov_b32 v20, s39
    s_mov_b64 exec, 1
    ds_write_b64 v2, v[20:21]
    s_mov_b64 exec, -1
    s_add_u32 s37, s37, 1
    s_waitcnt lgkmcnt(1)
    v_min_u32 v32, v32, v34
    v_readlane_b32 s41, v8, s37
    v_readfirstlane_b32 s38, v32
    v_readfirstlane_b32 s44, v33
    s_add_u32 s38, s38, 8
    s_cmp_gt_u32 s38, s37
    s_cbranch_scc0 L_full
L_free:
    s_cmp_eq_u32 s37, s70
    s_cbranch_scc1 L_event
L_pick:
    s_cmp_eq_u32 s44, 0
    s_cselect_b32 s44, s71, s44
    s_cmp_ge_u32 s44, 21
    s_cbranch_scc1 L_w21_27
    s_cmp_ge_u32 s44, 17
    s_cbranch_scc1 L_w17_20
    s_cmp_ge_u32 s44, 15
    s_cbranch_scc1 L_w15_16
    s_waitcnt vmcnt(14)
    buffer_load_dwordx4 v48, s[28:31], s41 offen offset:0 nt lds
    buffer_load_dwordx4 v49, s[28:31], s41 offen offset:1024 nt lds
    buffer_load_dwordx4 v50, s[28:31], s41 offen offset:2048 nt lds
    buffer_load_dwordx4 v51, s[28:31], s41 offen offset:3072 nt lds
    s_add_u32 m0, m0, 0x1000
    s_waitcnt vmcnt(14)
    buffer_load_dwordx4 v52, s[28:31], s41 offen offset:0 nt lds
    buffer_load_dwordx4 v53, s[28:31], s41 offen offset:1024 nt lds
    buffer_load_dwordx4 v54, s[28:31], s41 offen offset:2048 nt lds
    buffer_load_dwordx4 v55, s[28:31], s41 offen offset:3072 nt lds
    s_add_u32 m0, m0, 0x1000
    s_waitcnt vmcnt(14)
    buffer_load_dwordx4 v56, s[28:31], s41 offen offset:0 nt lds
    buffer_load_dwordx4 v57, s[28:31], s41 offen offset:1024 nt lds
    buffer_load_dwordx4 v58, s[28:31], s41 offen offset:2048 nt lds
    buffer_load_dwordx4 v59, s[28:31], s41 offen offset:3072 nt lds
    s_add_u32 m0, m0, 0x1000
    ds_read_b96 v[32:34], v2 offset:16
    s_waitcnt vmcnt(14)
    buffer_load_dwordx4 v60, s[28:31], s41 offen offset:0 nt lds
    buffer_load_dwordx4 v61, s[28:31], s41 offen offset:1024 nt lds
    buffer_load_dwordx4 v62, s[28:31], s41 offen offset:2048 nt lds
    buffer_load_dwordx4 v63, s[28:31], s41 offen offset:3072 nt lds
    s_add_u32 m0, m0, 0x1000
    s_branch L_common
L_w15_16:
    s_cmp_ge_u32 s44, 16
    s_cbranch_scc1 L_w16_16
    s_waitcnt vmcnt(15)
    buffer_load_dwordx4 v48, s[28:31], s41 offen offset:0 nt lds
    buffer_load_dwordx4 v49, s[28:31], s41 offen offset:1024 nt lds
    buffer_load_dwordx4 v50, s[28:31], s41 offen offset:2048 nt lds
    buffer_load_dwordx4 v51, s[28:31], s41 offen offset:3072 nt lds
    s_add_u32 m0, m0, 0x1000
    s_waitcnt vmcnt(15)
    buffer_load_dwordx4 v52, s[28:31], s41 offen offset:0 nt lds
    buffer_load_dwordx4 v53, s[28:31], s41 offen offset:1024 nt lds
    buffer_load_dwordx4 v54, s[28:31], s41 offen offset:2048 nt lds
    buffer_load_dwordx4 v55, s[28:31], s41 offen offset:3072 nt lds
    s_add_u32 m0, m0, 0x1000
    s_waitcnt vmcnt(15)
    buffer_load_dwordx4 v56, s[28:31], s41 offen offset:0 nt lds
    buffer_load_dwordx4 v57, s[28:31], s41 offen offset:1024 nt lds
    buffer_load_dwordx4 v58, s[28:31], s41 offen offset:2048 nt lds
    buffer_load_dwordx4 v59, s[28:31], s41 offen offset:3072 nt lds
    s_add_u32 m0, m0, 0x1000
    ds_read_b96 v[32:34], v2 offset:16
    s_waitcnt vmcnt(15)
    buffer_load_dwordx4 v60, s[28:31], s41 offen offset:0 nt lds
    buffer_load_dwordx4 v61, s[28:31], s41 offen offset:1024 nt lds
    buffer_load_dwordx4 v62, s[28:31], s41 offen offset:2048 nt lds
    buffer_load_dwordx4 v63, s[28:31], s41 offen offset:3072 nt lds
    s_add_u32 m0, m0, 0x1000
    s_branch L_common
L_w16_16:
    s_waitcnt vmcnt(16)
    buffer_load_dwordx4 v48, s[28:31], s41 offen offset:0 nt lds
    buffer_load_dwordx4 v49, s[28:31], s41 offen offset:1024 nt lds
    buffer_load_dwordx4 v50, s[28:31], s41 offen offset:2048 nt lds
    buffer_load_dwordx4 v51, s[28:31], s41 offen offset:3072 nt lds
    s_add_u32 m0, m0, 0x1000
    s_waitcnt vmcnt(16)
    buffer_load_dwordx4 v52, s[28:31], s41 offen offset:0 nt lds
    buffer_load_dwordx4 v53, s[28:31], s41 offen offset:1024 nt lds
    buffer_load_dwordx4 v54, s[28:31], s41 offen offset:2048 nt lds
    buffer_load_dwordx4 v55, s[28:31], s41 offen offset:3072 nt lds
    s_add_u32 m0, m0, 0x1000
    s_waitcnt vmcnt(16)
    buffer_load_dwordx4 v56, s[28:31], s41 offen offset:0 nt lds
    buffer_load_dwordx4 v57, s[28:31], s41 offen offset:1024 nt lds
    buffer_load_dwordx4 v58, s[28:31], s41 offen offset:2048 nt lds
    buffer_load_dwordx4 v59, s[28:31], s41 offen offset:3072 nt lds
    s_add_u32 m0, m0, 0x1000
    ds_read_b96 v[32:34], v2 offset:16
    s_waitcnt vmcnt(16)
    buffer_load_dwordx4 v60, s[28:31], s41 offen offset:0 nt lds
    buffer_load_dwordx4 v61, s[28:31], s41 offen offset:1024 nt lds
    buffer_load_dwordx4 v62, s[28:31], s41 offen offset:2048 nt lds
    buffer_load_dwordx4 v63, s[28:31], s41 offen offset:3072 nt lds
    s_add_u32 m0, m0, 0x1000
    s_branch L_common
L_w17_20:
    s_cmp_ge_u32 s44, 19
    s_cbranch_scc1 L_w19_20
    s_cmp_ge_u32 s44, 18
    s_cbranch_scc1 L_w18_18
    s_waitcnt vmcnt(17)
    buffer_load_dwordx4 v48, s[28:31], s41 offen offset:0 nt lds
    buffer_load_dwordx4 v49, s[28:31], s41 offen offset:1024 nt lds
    buffer_load_dwordx4 v50, s[28:31], s41 offen offset:2048 nt lds
    buffer_load_dwordx4 v51, s[28:31], s41 offen offset:3072 nt lds
    s_add_u32 m0, m0, 0x1000
    s_waitcnt vmcnt(17)
    buffer_load_dwordx4 v52, s[28:31], s41 offen offset:0 nt lds
    buffer_load_dwordx4 v53, s[28:31], s41 offen offset:1024 nt lds
    buffer_load_dwordx4 v54, s[28:31], s41 offen offset:2048 nt lds
    buffer_load_dwordx4 v55, s[28:31], s41 offen offset:3072 nt lds
    s_add_u32 m0, m0, 0x1000
    s_waitcnt vmcnt(17)
    buffer_load_dwordx4 v56, s[28:31], s41 offen offset:0 nt lds
    buffer_load_dwordx4 v57, s[28:31], s41 offen offset:1024 nt lds
    buffer_load_dwordx4 v58, s[28:31], s41 offen offset:2048 nt lds
    buffer_load_dwordx4 v59, s[28:31], s41 offen offset:3072 nt lds
    s_add_u32 m0, m0, 0x1000
    ds_read_b96 v[32:34], v2 offset:16
    s_waitcnt vmcnt(17)
    buffer_load_dwordx4 v60, s[28:31], s41 offen offset:0 nt lds
    buffer_load_dwordx4 v61, s[28:31], s41 offen offset:1024 nt lds
    buffer_load_dwordx4 v62, s[28:31], s41 offen offset:2048 nt lds
    buffer_load_dwordx4 v63, s[28:31], s41 offen offset:3072 nt lds
    s_add_u32 m0, m0, 0x1000
    s_branch L_common
L_w18_18:
    s_waitcnt vmcnt(18)
    buffer_load_dwordx4 v48, s[28:31], s41 offen offset:0 nt lds
    buffer_load_dwordx4 v49, s[28:31], s41 offen offset:1024 nt lds
    buffer_load_dwordx4 v50, s[28:31], s41 offen offset:2048 nt lds
    buffer_load_dwordx4 v51, s[28:31], s41 offen offset:3072 nt lds
    s_add_u32 m0, m0, 0x1000
    s_waitcnt vmcnt(18)
    buffer_load_dwordx4 v52, s[28:31], s41 offen offset:0 nt lds
    buffer_load_dwordx4 v53, s[28:31], s41 offen offset:1024 nt lds
    buffer_load_dwordx4 v54, s[28:31], s41 offen offset:2048 nt lds
    buffer_load_dwordx4 v55, s[28:31], s41 offen offset:3072 nt lds
    s_add_u32 m0, m0, 0x1000
    s_waitcnt vmcnt(18)
    buffer_load_dwordx4 v56, s[28:31], s41 offen offset:0 nt lds
    buffer_load_dwordx4 v57, s[28:31], s41 offen offset:1024 nt lds
    buffer_load_dwordx4 v58, s[28:31], s41 offen offset:2048 nt lds
    buffer_load_dwordx4 v59, s[28:31], s41 offen offset:3072 nt lds
    s_add_u32 m0, m0, 0x1000
    ds_read_b96 v[32:34], v2 offset:16
    s_waitcnt vmcnt(18)
    buffer_load_dwordx4 v60, s[28:31], s41 offen offset:0 nt lds
    buffer_load_dwordx4 v61, s[28:31], s41 offen offset:1024 nt lds
    buffer_load_dwordx4 v62, s[28:31], s41 offen offset:2048 nt lds
    buffer_load_dwordx4 v63, s[28:31], s41 offen offset:3072 nt lds
    s_add_u32 m0, m0, 0x1000
    s_branch L_common
L_w19_20:
    s_cmp_ge_u32 s44, 20
    s_cbranch_scc1 L_w20_20
    s_waitcnt vmcnt(19)
    buffer_load_dwordx4 v48, s[28:31], s41 offen offset:0 nt lds
    buffer_load_dwordx4 v49, s[28:31], s41 offen offset:1024 nt lds
    buffer_load_dwordx4 v50, s[28:31], s41 offen offset:2048 nt lds
    buffer_load_dwordx4 v51, s[28:31], s41 offen offset:3072 nt lds
    s_add_u32 m0, m0, 0x1000
    s_waitcnt vmcnt(19)
    buffer_load_dwordx4 v52, s[28:31], s41 offen offset:0 nt lds
    buffer_load_dwordx4 v53, s[28:31], s41 offen offset:1024 nt lds
    buffer_load_dwordx4 v54, s[28:31], s41 offen offset:2048 nt lds
    buffer_load_dwordx4 v55, s[28:31], s41 offen offset:3072 nt lds
    s_add_u32 m0, m0, 0x1000
    s_waitcnt vmcnt(19)
    buffer_load_dwordx4 v56, s[28:31], s41 offen offset:0 nt lds
    buffer_load_dwordx4 v57, s[28:31], s41 offen offset:1024 nt lds
    buffer_load_dwordx4 v58, s[28:31], s41 offen offset:2048 nt lds
    buffer_load_dwordx4 v59, s[28:31], s41 offen offset:3072 nt lds
    s_add_u32 m0, m0, 0x1000
    ds_read_b96 v[32:34], v2 offset:16
    s_waitcnt vmcnt(19)
    buffer_load_dwordx4 v60, s[28:31], s41 offen offset:0 nt lds
    buffer_load_dwordx4 v61, s[28:31], s41 offen offset:1024 nt lds
    buffer_load_dwordx4 v62, s[28:31], s41 offen offset:2048 nt lds
    buffer_load_dwordx4 v63, s[28:31], s41 offen offset:3072 nt lds
    s_add_u32 m0, m0, 0x1000
    s_branch L_common
L_w20_20:
    s_waitcnt vmcnt(20)
    buffer_load_dwordx4 v48, s[28:31], s41 offen offset:0 nt lds
    buffer_load_dwordx4 v49, s[28:31], s41 offen offset:1024 nt lds
    buffer_load_dwordx4 v50, s[28:31], s41 offen offset:2048 nt lds
    buffer_load_dwordx4 v51, s[28:31], s41 offen offset:3072 nt lds
    s_add_u32 m0, m0, 0x1000
    s_waitcnt vmcnt(20)
    buffer_load_dwordx4 v52, s[28:31], s41 offen offset:0 nt lds
    buffer_load_dwordx4 v53, s[28:31], s41 offen offset:1024 nt lds
    buffer_load_dwordx4 v54, s[28:31], s41 offen offset:2048 nt lds
    buffer_load_dwordx4 v55, s[28:31], s41 offen offset:3072 nt lds
    s_add_u32 m0, m0, 0x1000
    s_waitcnt vmcnt(20)
    buffer_load_dwordx4 v56, s[28:31], s41 offen offset:0 nt lds
    buffer_load_dwordx4 v57, s[28:31], s41 offen offset:1024 nt lds
    buffer_load_dwordx4 v58, s[28:31], s41 offen offset:2048 nt lds
    buffer_load_dwordx4 v59, s[28:31], s41 offen offset:3072 nt lds
    s_add_u32 m0, m0, 0x1000
    ds_read_b96 v[32:34], v2 offset:16
    s_waitcnt vmcnt(20)
    buffer_load_dwordx4 v60, s[28:31], s41 offen offset:0 nt lds
    buffer_load_dwordx4 v61, s[28:31], s41 offen offset:1024 nt lds
    buffer_load_dwordx4 v62, s[28:31], s41 offen offset:2048 nt lds
    buffer_load_dwordx4 v63, s[28:31], s41 offen offset:3072 nt lds
    s_add_u32 m0, m0, 0x1000
    s_branch L_common
L_w21_27:
    s_cmp_ge_u32 s44, 24
    s_cbranch_scc1 L_w24_27
    s_cmp_ge_u32 s44, 22
    s_cbranch_scc1 L_w22_23
    s_waitcnt vmcnt(21)
    buffer_load_dwordx4 v48, s[28:31], s41 offen offset:0 nt lds
    buffer_load_dwordx4 v49, s[28:31], s41 offen offset:1024 nt lds
    buffer_load_dwordx4 v50, s[28:31], s41 offen offset:2048 nt lds
    buffer_load_dwordx4 v51, s[28:31], s41 offen offset:3072 nt lds
    s_add_u32 m0, m0, 0x1000
    s_waitcnt vmcnt(21)
    buffer_load_dwordx4 v52, s[28:31], s41 offen offset:0 nt lds
    buffer_load_dwordx4 v53, s[28:31], s41 offen offset:1024 nt lds
    buffer_load_dwordx4 v54, s[28:31], s41 offen offset:2048 nt lds
    buffer_load_dwordx4 v55, s[28:31], s41 offen offset:3072 nt lds
    s_add_u32 m0, m0, 0x1000
    s_waitcnt vmcnt(21)
    buffer_load_dwordx4 v56, s[28:31], s41 offen offset:0 nt lds
    buffer_load_dwordx4 v57, s[28:31], s41 offen offset:1024 nt lds
    buffer_load_dwordx4 v58, s[28:31], s41 offen offset:2048 nt lds
    buffer_load_dwordx4 v59, s[28:31], s41 offen offset:3072 nt lds
    s_add_u32 m0, m0, 0x1000
    ds_read_b96 v[32:34], v2 offset:16
    s_waitcnt vmcnt(21)
    buffer_load_dwordx4 v60, s[28:31], s41 offen offset:0 nt lds
    buffer_load_dwordx4 v61, s[28:31], s41 offen offset:1024 nt lds
    buffer_load_dwordx4 v62, s[28:31], s41 offen offset:2048 nt lds
    buffer_load_dwordx4 v63, s[28:31], s41 offen offset:3072 nt lds
    s_add_u32 m0, m0, 0x1000
    s_branch L_common
L_w22_23:
    s_cmp_ge_u32 s44, 23
    s_cbranch_scc1 L_w23_23
    s_waitcnt vmcnt(22)
    buffer_load_dwordx4 v48, s[28:31], s41 offen offset:0 nt lds
    buffer_load_dwordx4 v49, s[28:31], s41 offen offset:1024 nt lds
    buffer_load_dwordx4 v50, s[28:31], s41 offen offset:2048 nt lds
    buffer_load_dwordx4 v51, s[28:31], s41 offen offset:3072 nt lds
    s_add_u32 m0, m0, 0x1000
    s_waitcnt vmcnt(22)
    buffer_load_dwordx4 v52, s[28:31], s41 offen offset:0 nt lds
    buffer_load_dwordx4 v53, s[28:31], s41 offen offset:1024 nt lds
    buffer_load_dwordx4 v54, s[28:31], s41 offen offset:2048 nt lds
    buffer_load_dwordx4 v55, s[28:31], s41 offen offset:3072 nt lds
    s_add_u32 m0, m0, 0x1000
    s_waitcnt vmcnt(22)
    buffer_load_dwordx4 v56, s[28:31], s41 offen offset:0 nt lds
    buffer_load_dwordx4 v57, s[28:31], s41 offen offset:1024 nt lds
    buffer_load_dwordx4 v58, s[28:31], s41 offen offset:2048 nt lds
    buffer_load_dwordx4 v59, s[28:31], s41 offen offset:3072 nt lds
    s_add_u32 m0, m0, 0x1000
    ds_read_b96 v[32:34], v2 offset:16
    s_waitcnt vmcnt(22)
    buffer_load_dwordx4 v60, s[28:31], s41 offen offset:0 nt lds
    buffer_load_dwordx4 v61, s[28:31], s41 offen offset:1024 nt lds
    buffer_load_dwordx4 v62, s[28:31], s41 offen offset:2048 nt lds
    buffer_load_dwordx4 v63, s[28:31], s41 offen offset:3072 nt lds
    s_add_u32 m0, m0, 0x1000
    s_branch L_common
L_w23_23:
    s_waitcnt vmcnt(23)
    buffer_load_dwordx4 v48, s[28:31], s41 offen offset:0 nt lds
    buffer_load_dwordx4 v49, s[28:31], s41 offen offset:1024 nt lds
    buffer_load_dwordx4 v50, s[28:31], s41 offen offset:2048 nt lds
    buffer_load_dwordx4 v51, s[28:31], s41 offen offset:3072 nt lds
    s_add_u32 m0, m0, 0x1000
    s_waitcnt vmcnt(23)
    buffer_load_dwordx4 v52, s[28:31], s41 offen offset:0 nt lds
    buffer_load_dwordx4 v53, s[28:31], s41 offen offset:1024 nt lds
    buffer_load_dwordx4 v54, s[28:31], s41 offen offset:2048 nt lds
    buffer_load_dwordx4 v55, s[28:31], s41 offen offset:3072 nt lds
    s_add_u32 m0, m0, 0x1000
    s_waitcnt vmcnt(23)
    buffer_load_dwordx4 v56, s[28:31], s41 offen offset:0 nt lds
    buffer_load_dwordx4 v57, s[28:31], s41 offen offset:1024 nt lds
    buffer_load_dwordx4 v58, s[28:31], s41 offen offset:2048 nt lds
    buffer_load_dwordx4 v59, s[28:31], s41 offen offset:3072 nt lds
    s_add_u32 m0, m0, 0x1000
    ds_read_b96 v[32:34], v2 offset:16
    s_waitcnt vmcnt(23)
    buffer_load_dwordx4 v60, s[28:31], s41 offen offset:0 nt lds
    buffer_load_dwordx4 v61, s[28:31], s41 offen offset:1024 nt lds
    buffer_load_dwordx4 v62, s[28:31], s41 offen offset:2048 nt lds
    buffer_load_dwordx4 v63, s[28:31], s41 offen offset:3072 nt lds
    s_add_u32 m0, m0, 0x1000
    s_branch L_common
L_w24_27:
    s_cmp_ge_u32 s44, 26
    s_cbranch_scc1 L_w26_27
    s_cmp_ge_u32 s44, 25
    s_cbranch_scc1 L_w25_25
    s_waitcnt vmcnt(24)
    buffer_load_dwordx4 v48, s[28:31], s41 offen offset:0 nt lds
    buffer_load_dwordx4 v49, s[28:31], s41 offen offset:1024 nt lds
    buffer_load_dwordx4 v50, s[28:31], s41 offen offset:2048 nt lds
    buffer_load_dwordx4 v51, s[28:31], s41 offen offset:3072 nt lds
    s_add_u32 m0, m0, 0x1000
    s_waitcnt vmcnt(24)
    buffer_load_dwordx4 v52, s[28:31], s41 offen offset:0 nt lds
    buffer_load_dwordx4 v53, s[28:31], s41 offen offset:1024 nt lds
    buffer_load_dwordx4 v54, s[28:31], s41 offen offset:2048 nt lds
    buffer_load_dwordx4 v55, s[28:31], s41 offen offset:3072 nt lds
    s_add_u32 m0, m0, 0x1000
    s_waitcnt vmcnt(24)
    buffer_load_dwordx4 v56, s[28:31], s41 offen offset:0 nt lds
    buffer_load_dwordx4 v57, s[28:31], s41 offen offset:1024 nt lds
    buffer_load_dwordx4 v58, s[28:31], s41 offen offset:2048 nt lds
    buffer_load_dwordx4 v59, s[28:31], s41 offen offset:3072 nt lds
    s_add_u32 m0, m0, 0x1000
    ds_read_b96 v[32:34], v2 offset:16
    s_waitcnt vmcnt(24)
    buffer_load_dwordx4 v60, s[28:31], s41 offen offset:0 nt lds
    buffer_load_dwordx4 v61, s[28:31], s41 offen offset:1024 nt lds
    buffer_load_dwordx4 v62, s[28:31], s41 offen offset:2048 nt lds
    buffer_load_dwordx4 v63, s[28:31], s41 offen offset:3072 nt lds
    s_add_u32 m0, m0, 0x1000
    s_branch L_common
L_w25_25:
    s_waitcnt vmcnt(25)
    buffer_load_dwordx4 v48, s[28:31], s41 offen offset:0 nt lds
    buffer_load_dwordx4 v49, s[28:31], s41 offen offset:1024 nt lds
    buffer_load_dwordx4 v50, s[28:31], s41 offen offset:2048 nt lds
    buffer_load_dwordx4 v51, s[28:31], s41 offen offset:3072 nt lds
    s_add_u32 m0, m0, 0x1000
    s_waitcnt vmcnt(25)
    buffer_load_dwordx4 v52, s[28:31], s41 offen offset:0 nt lds
    buffer_load_dwordx4 v53, s[28:31], s41 offen offset:1024 nt lds
    buffer_load_dwordx4 v54, s[28:31], s41 offen offset:2048 nt lds
    buffer_load_dwordx4 v55, s[28:31], s41 offen offset:3072 nt lds
    s_add_u32 m0, m0, 0x1000
    s_waitcnt vmcnt(25)
    buffer_load_dwordx4 v56, s[28:31], s41 offen offset:0 nt lds
    buffer_load_dwordx4 v57, s[28:31], s41 offen offset:1024 nt lds
    buffer_load_dwordx4 v58, s[28:31], s41 offen offset:2048 nt lds
    buffer_load_dwordx4 v59, s[28:31], s41 offen offset:3072 nt lds
    s_add_u32 m0, m0, 0x1000
    ds_read_b96 v[32:34], v2 offset:16
    s_waitcnt vmcnt(25)
    buffer_load_dwordx4 v60, s[28:31], s41 offen offset:0 nt lds
    buffer_load_dwordx4 v61, s[28:31], s41 offen offset:1024 nt lds
    buffer_load_dwordx4 v62, s[28:31], s41 offen offset:2048 nt lds
    buffer_load_dwordx4 v63, s[28:31], s41 offen offset:3072 nt lds
    s_add_u32 m0, m0, 0x1000
    s_branch L_common
L_w26_27:
    s_cmp_ge_u32 s44, 27
    s_cbranch_scc1 L_w27_27
    s_waitcnt vmcnt(26)
    buffer_load_dwordx4 v48, s[28:31], s41 offen offset:0 nt lds
    buffer_load_dwordx4 v49, s[28:31], s41 offen offset:1024 nt lds
    buffer_load_dwordx4 v50, s[28:31], s41 offen offset:2048 nt lds
    buffer_load_dwordx4 v51, s[28:31], s41 offen offset:3072 nt lds
    s_add_u32 m0, m0, 0x1000
    s_waitcnt vmcnt(26)
    buffer_load_dwordx4 v52, s[28:31], s41 offen offset:0 nt lds
    buffer_load_dwordx4 v53, s[28:31], s41 offen offset:1024 nt lds
    buffer_load_dwordx4 v54, s[28:31], s41 offen offset:2048 nt lds
    buffer_load_dwordx4 v55, s[28:31], s41 offen offset:3072 nt lds
    s_add_u32 m0, m0, 0x1000
    s_waitcnt vmcnt(26)
    buffer_load_dwordx4 v56, s[28:31], s41 offen offset:0 nt lds
    buffer_load_dwordx4 v57, s[28:31], s41 offen offset:1024 nt lds
    buffer_load_dwordx4 v58, s[28:31], s41 offen offset:2048 nt lds
    buffer_load_dwordx4 v59, s[28:31], s41 offen offset:3072 nt lds
    s_add_u32 m0, m0, 0x1000
    ds_read_b96 v[32:34], v2 offset:16
    s_waitcnt vmcnt(26)
    buffer_load_dwordx4 v60, s[28:31], s41 offen offset:0 nt lds
    buffer_load_dwordx4 v61, s[28:31], s41 offen offset:1024 nt lds
    buffer_load_dwordx4 v62, s[28:31], s41 offen offset:2048 nt lds
    buffer_load_dwordx4 v63, s[28:31], s41 offen offset:3072 nt lds
    s_add_u32 m0, m0, 0x1000
    s_branch L_common
L_w27_27:
    s_waitcnt vmcnt(27)
    buffer_load_dwordx4 v48, s[28:31], s41 offen offset:0 nt lds
    buffer_load_dwordx4 v49, s[28:31], s41 offen offset:1024 nt lds
    buffer_load_dwordx4 v50, s[28:31], s41 offen offset:2048 nt lds
    buffer_load_dwordx4 v51, s[28:31], s41 offen offset:3072 nt lds
    s_add_u32 m0, m0, 0x1000
    s_waitcnt vmcnt(27)
    buffer_load_dwordx4 v52, s[28:31], s41 offen offset:0 nt lds
    buffer_load_dwordx4 v53, s[28:31], s41 offen offset:1024 nt lds
    buffer_load_dwordx4 v54, s[28:31], s41 offen offset:2048 nt lds
    buffer_load_dwordx4 v55, s[28:31], s41 offen offset:3072 nt lds
    s_add_u32 m0, m0, 0x1000
    s_waitcnt vmcnt(27)
    buffer_load_dwordx4 v56, s[28:31], s41 offen offset:0 nt lds
    buffer_load_dwordx4 v57, s[28:31], s41 offen offset:1024 nt lds
    buffer_load_dwordx4 v58, s[28:31], s41 offen offset:2048 nt lds
    buffer_load_dwordx4 v59, s[28:31], s41 offen offset:3072 nt lds
    s_add_u32 m0, m0, 0x1000
    ds_read_b96 v[32:34], v2 offset:16
    s_waitcnt vmcnt(27)
    buffer_load_dwordx4 v60, s[28:31], s41 offen offset:0 nt lds
    buffer_load_dwordx4 v61, s[28:31], s41 offen offset:1024 nt lds
    buffer_load_dwordx4 v62, s[28:31], s41 offen offset:2048 nt lds
    buffer_load_dwordx4 v63, s[28:31], s41 offen offset:3072 nt lds
    s_add_u32 m0, m0, 0x1000
    s_branch L_common
L_full:
    ds_read_b96 v[32:34], v2 offset:16
    s_waitcnt lgkmcnt(0)
    v_min_u32 v32, v32, v34
    s_nop 0
    v_readfirstlane_b32 s38, v32
    s_add_u32 s38, s38, 8
    s_cmp_gt_u32 s38, s37
    s_cbranch_scc1 L_free
    s_sub_u32 s27, s27, 1
    s_cbranch_scc1 L_done
    s_branch L_full
L_event:
    s_cmp_eq_u32 s37, 128
    s_cbranch_scc1 L_wo
    s_cmp_eq_u32 s37, 40
    s_cbranch_scc1 L_wo
    v_swap_b32 v48, v64
    v_swap_b32 v49, v65
    v_swap_b32 v50, v66
    v_swap_b32 v51, v67
    v_swap_b32 v52, v68
    v_swap_b32 v53, v69
    v_swap_b32 v54, v70
    v_swap_b32 v55, v71
    v_swap_b32 v56, v72
    v_swap_b32 v57, v73
    v_swap_b32 v58, v74
    v_swap_b32 v59, v75
    v_swap_b32 v60, v76
    v_swap_b32 v61, v77
    v_swap_b32 v62, v78
    v_swap_b32 v63, v79
    s_add_u32 s28, s14, s49
    s_addc_u32 s29, s15, 0
    s_sub_u32 s28, s28, 3072
    s_subb_u32 s29, s29, 0
    s_and_b32 s29, s29, 0xffff
    s_mov_b64 s[14:15], s[16:17]
    s_mov_b64 s[16:17], s[18:19]
    s_add_u32 s70, s37, 32
    s_cmp_eq_u32 s37, 32
    s_cselect_b32 s70, 40, s70
    s_branch L_pick
L_woback:
    s_mov_b64 exec, -1
    s_mov_b32 m0, s39
    s_mov_b32 s70, 64
    s_mov_b32 s66, 0
    s_add_u32 s52, s20, s68
    s_addc_u32 s53, s21, 0
    s_sub_u32 s52, s52, 3072
    s_subb_u32 s53, s53, 0
    s_and_b32 s53, s53, 0xffff
    s_branch L_pick
L_wo:
    s_mov_b32 s39, m0
    s_mov_b32 m0, s66
    s_sub_u32 s40, s37, 1
    v_mov_b32 v21, s40
    v_mov_b32 v22, s37
    s_mov_b64 exec, 1
    s_cmp_eq_u32 s37, 128
    s_cselect_b32 s40, s44, 0
    s_cmp_ge_u32 s40, 20
    s_cbranch_scc1 L_wogo
    s_waitcnt vmcnt(16)
    ds_write_b32 v2, v21
    s_waitcnt vmcnt(10)
L_wogo:
    s_mov_b64 exec, -1
    s_mov_b32 s40, 0
    s_waitcnt vmcnt(28)
    buffer_load_dwordx4 v26, s[52:55], s40 offen offset:0 nt lds
    buffer_load_dwordx4 v27, s[52:55], s40 offen offset:1024 nt lds
    buffer_load_dwordx4 v28, s[52:55], s40 offen offset:2048 nt lds
    buffer_load_dwordx4 v29, s[52:55], s40 offen offset:3072 nt lds
    s_add_u32 m0, m0, 0x1000
    s_mov_b32 s40, 7168
    s_waitcnt vmcnt(28)
    buffer_load_dwordx4 v26, s[52:55], s40 offen offset:0 nt lds
    buffer_load_dwordx4 v27, s[52:55], s40 offen offset:1024 nt lds
    buffer_load_dwordx4 v28, s[52:55], s40 offen offset:2048 nt lds
    buffer_load_dwordx4 v29, s[52:55], s40 offen offset:3072 nt lds
    s_add_u32 m0, m0, 0x1000
    s_mov_b32 s40, 28672
    s_waitcnt vmcnt(28)
    buffer_load_dwordx4 v26, s[52:55], s40 offen offset:0 nt lds
    buffer_load_dwordx4 v27, s[52:55], s40 offen offset:1024 nt lds
    buffer_load_dwordx4 v28, s[52:55], s40 offen offset:2048 nt lds
    buffer_load_dwordx4 v29, s[52:55], s40 offen offset:3072 nt lds
    s_add_u32 m0, m0, 0x1000
    s_mov_b32 s40, 35840
    s_waitcnt vmcnt(28)
    buffer_load_dwordx4 v26, s[52:55], s40 offen offset:0 nt lds
    buffer_load_dwordx4 v27, s[52:55], s40 offen offset:1024 nt lds
    buffer_load_dwordx4 v28, s[52:55], s40 offen offset:2048 nt lds
    buffer_load_dwordx4 v29, s[52:55], s40 offen offset:3072 nt lds
    s_add_u32 m0, m0, 0x1000
    s_mov_b64 exec, 1
    ds_write_b32 v2, v21
    s_waitcnt vmcnt(16)
    ds_write_b32 v2, v22
    s_cmp_lg_u32 s37, 128
    s_cbranch_scc1 L_woback
    v_mov_b32 v21, 129
    v_mov_b32 v22, 130
    s_waitcnt vmcnt(8)
    ds_write_b32 v2, v21
    s_waitcnt vmcnt(0)
    ds_write_b32 v2, v22
    s_endpgm
L_ctl:
    s_and_b32 s3, s2, 7
    s_lshl_b32 s41, s6, 3
    s_add_u32 s3, s3, s41
    s_lshl_b32 s3, s3, 3
    s_add_u32 s3, s3, 393216
    v_mov_b32 v10, s3
    v_and_b32 v3, 15, v0
    v_lshlrev_b32 v11, 3, v3
    v_add_u32 v11, 388864, v11
    s_load_dwordx4 s[16:19], s[0:1], 48
    s_load_dwordx2 s[8:9], s[0:1], 32
    s_load_dwordx4 s[20:23], s[0:1], 72
    s_and_b32 s68, s2, 63
    s_lshl_b32 s68, s68, 21
    s_mov_b32 s59, 14
    s_mov_b32 s36, 0
    s_cmp_gt_u32 s36, 2
    s_cbranch_scc1 L_ok0
L_sp0:
    s_sleep 8
    ds_read_b32 v20, v2 offset:44
    s_sub_u32 s27, s27, 1
    s_cbranch_scc1 L_done
    s_waitcnt lgkmcnt(0)
    v_readfirstlane_b32 s36, v20
    s_cmp_gt_u32 s36, 2
    s_cbranch_scc0 L_sp0
L_ok0:
    ds_read_b32 v19, v2 offset:28
    s_mov_b32 s36, 0
    s_mov_b32 s50, 1
    s_mov_b32 s53, 852
    s_mov_b32 s52, 0
    s_mov_b32 s49, 3
    s_mov_b32 s55, 0
    s_lshl_b32 s54, s4, 1
    s_add_u32 s54, s54, s5
    s_add_u32 s54, s54, s6
L_c0:
    ds_read_b32 v20, v2 offset:4
    s_waitcnt lgkmcnt(0)
    v_readfirstlane_b32 s36, v20
    s_cmp_ge_u32 s36, 126
    s_cbranch_scc1 L_red
L_c:
    s_sleep 1
    ds_read_b32 v20, v2 offset:4
    s_sub_u32 s27, s27, 1
    s_cbranch_scc1 L_done
    s_waitcnt lgkmcnt(0)
    v_readfirstlane_b32 s37, v20
    s_cmp_eq_u32 s37, s36
    s_cbranch_scc1 L_c
    s_memrealtime s[38:39]
    s_mov_b32 s36, s37
    s_cmp_ge_u32 s37, 126
    s_waitcnt lgkmcnt(0)
    s_cbranch_scc1 L_red
    s_cmp_le_u32 s50, 2
    s_cbranch_scc1 L_c_ck
    s_mul_i32 s3, s37, s53
    s_lshr_b32 s3, s3, 4
    s_sub_u32 s39, s38, s55
    s_sub_u32 s39, s39, s3
    s_max_i32 s39, s39, -1000
    s_min_i32 s39, s39, 1000
    s_lshr_b32 s3, s37, 2
    s_add_u32 s3, s3, 8
    s_cmp_gt_i32 s39, 0
    s_cselect_b32 s3, 88, s3
    s_mul_i32 s39, s39, s3
    s_ashr_i32 s39, s39, 8
    s_brev_b32 s3, s37
    s_lshr_b32 s3, s3, 30
    s_add_i32 s39, s39, s3
    s_add_i32 s39, s39, 68
    s_ashr_i32 s39, s39, 2
    s_max_i32 s39, s39, 14
    s_min_i32 s39, s39, 27
    v_mov_b32 v20, s39
    s_mov_b64 exec, 1
    ds_write_b32 v2, v20 offset:20
    s_mov_b64 exec, -1
    s_cmp_lt_u32 s37, s59
    s_cbranch_scc1 L_c_nt
    s_add_u32 s14, s14, s68
    s_addc_u32 s15, s15, 0
    s_load_dword s99, s[14:15], 0
    s_add_u32 s16, s16, s68
    s_addc_u32 s17, s17, 0
    s_load_dword s99, s[16:17], 0
    s_add_u32 s18, s18, s68
    s_addc_u32 s19, s19, 0
    s_load_dword s99, s[18:19], 0
    s_mul_i32 s3, s4, 458752
    s_add_u32 s8, s8, s3
    s_addc_u32 s9, s9, 0
    s_load_dword s99, s[8:9], 0
    s_load_dword s99, s[8:9], 458748
    s_add_u32 s20, s20, s3
    s_addc_u32 s21, s21, 0
    s_load_dword s99, s[20:21], 0
    s_load_dword s99, s[20:21], 458748
    s_load_dword s99, s[22:23], 0
    s_movk_i32 s59, 999
    s_branch L_c0
L_c_nt:
L_c_ck:
    s_cmp_lt_u32 s37, s49
    s_cbranch_scc1 L_c
    s_sub_u32 s3, s37, s49
    s_mul_i32 s3, s3, s53
    s_lshr_b32 s3, s3, 4
    s_sub_u32 s38, s38, s3
    v_mov_b32 v18, s38
    v_add_u32 v10, 4352, v10
    v_add_u32 v11, 4352, v11
    s_xor_b32 s41, s54, s50
    s_and_b32 s41, s41, 15
    s_cbranch_scc1 L_c_np
    s_cmp_gt_u32 s49, 110
    s_cbranch_scc1 L_c_np
    s_mov_b64 exec, 1
    global_store_dwordx2 v10, v[18:19], s[24:25] sc1
    s_mov_b64 exec, -1
L_c_np:
    s_cmp_le_u32 s50, 1
    s_cbranch_scc1 L_c_nx
    global_load_dwordx2 v[12:13], v11, s[24:25] sc1
    s_waitcnt vmcnt(0)
    v_cmp_eq_u32 vcc, v19, v13
    v_sub_u32 v12, v12, v18
    s_nop 0
    v_cndmask_b32 v12, 0, v12, vcc
    s_nop 1
    v_add_u32_dpp v12, v12, v12 row_ror:8 row_mask:0xf bank_mask:0xf
    s_nop 1
    v_add_u32_dpp v12, v12, v12 row_ror:4 row_mask:0xf bank_mask:0xf
    s_nop 1
    v_add_u32_dpp v12, v12, v12 row_ror:2 row_mask:0xf bank_mask:0xf
    s_nop 1
    v_add_u32_dpp v12, v12, v12 row_ror:1 row_mask:0xf bank_mask:0xf
    v_ashrrev_i32 v12, 4, v12
    v_add_u32 v12, v12, v18
    s_nop 0
    v_readfirstlane_b32 s41, v12
    s_cmp_eq_u32 s50, 2
    s_cbranch_scc1 L_c_fs
    s_sub_u32 s3, s41, s52
    s_lshl_b32 s3, s3, 1
    s_sub_u32 s3, s3, s53
    s_cmp_gt_i32 s3, 0
    s_cselect_b32 s39, 3, 2
    s_ashr_i32 s3, s3, s39
    s_add_u32 s53, s53, s3
    s_max_i32 s53, s53, 1
L_c_fs:
    s_mov_b32 s52, s41
    s_sub_u32 s3, s49, 8
    s_mul_i32 s3, s3, s53
    s_lshr_b32 s3, s3, 4
    s_sub_u32 s55, s41, s3
L_c_nx:
    s_add_u32 s50, s50, 1
    s_add_u32 s49, s49, 8
    s_cmp_gt_u32 s49, 118
    s_cselect_b32 s49, 999, s49
    s_branch L_c0
L_red:
    s_cmp_ge_u32 s5, 28
    s_cbranch_scc1 L_done
    s_bitcmp1_b32 s5, 0
    s_cbranch_scc1 L_done
    s_mul_i32 s51, s4, 14
    s_lshr_b32 s3, s5, 1
    s_add_u32 s51, s51, s3
    s_and_b32 s69, s5, 1
    s_mul_i32 s3, s69, 112
    s_add_u32 s3, s3, s51
    s_lshl_b32 s3, s3, 12
    s_add_u32 s3, s3, 1048576
    v_lshlrev_b32 v44, 4, v0
    v_add_u32 v44, s3, v44
    s_bfe_u32 s3, s51, 0x10001
    s_mul_i32 s3, s3, 7168
    s_mul_i32 s39, s69, 896
    s_add_u32 s3, s3, s39
    s_lshr_b32 s39, s51, 2
    s_lshl_b32 s39, s39, 5
    s_add_u32 s3, s3, s39
    s_and_b32 s39, s51, 1
    s_lshl_b32 s39, s39, 4
    s_add_u32 s3, s3, s39
    v_lshrrev_b32 v45, 4, v0
    v_mul_u32_u24 v45, 1792, v45
    v_and_b32 v7, 7, v0
    v_lshl_add_u32 v45, v7, 1, v45
    v_add_u32 v45, s3, v45
    s_movk_i32 s50, 0xfff
    v_readfirstlane_b32 s26, v19
    s_and_b32 s49, s26, 0xfff
    s_xor_b32 s49, s49, 0x800
    s_mov_b32 s66, 0x00ff00ff
    s_mov_b32 s67, s66
    s_mov_b64 s[56:57], -1
    s_mov_b64 s[58:59], -1
    s_mov_b64 s[60:61], -1
    s_mov_b64 s[62:63], -1
    s_barrier
L_ypoll:
    s_mov_b64 exec, s[56:57]
    global_load_dwordx4 v[24:27], v44, s[24:25] offset:0 sc1
    s_mov_b64 exec, s[58:59]
    global_load_dwordx4 v[28:31], v44, s[24:25] offset:1024 sc1
    s_mov_b64 exec, s[60:61]
    global_load_dwordx4 v[32:35], v44, s[24:25] offset:2048 sc1
    s_mov_b64 exec, s[62:63]
    global_load_dwordx4 v[36:39], v44, s[24:25] offset:3072 sc1
    s_mov_b64 exec, -1
    s_sub_u32 s27, s27, 8
    s_cbranch_scc1 L_done
    s_waitcnt vmcnt(3)
    v_bitop3_b32 v20, v24, v25, s26 bitop3:0x7e
    v_bitop3_b32 v21, v26, v27, s26 bitop3:0x7e
    v_bitop3_b32 v20, v20, v21, s50 bitop3:0xa8
    v_cmp_ne_u32 s[56:57], 0, v20
    v_xor_b32 v40, s49, v24
    v_xor_b32 v41, s49, v25
    v_xor_b32 v42, s49, v26
    v_xor_b32 v43, s49, v27
    s_waitcnt vmcnt(2)
    v_bitop3_b32 v20, v28, v29, s26 bitop3:0x7e
    v_bitop3_b32 v21, v30, v31, s26 bitop3:0x7e
    v_bitop3_b32 v20, v20, v21, s50 bitop3:0xa8
    v_cmp_ne_u32 s[58:59], 0, v20
    v_xor_b32 v46, s49, v28
    v_xor_b32 v47, s49, v29
    v_xor_b32 v48, s49, v30
    v_xor_b32 v49, s49, v31
    v_add_f32 v40, v40, v46
    v_add_f32 v41, v41, v47
    v_add_f32 v42, v42, v48
    v_add_f32 v43, v43, v49
    s_or_b64 s[64:65], s[56:57], s[58:59]
    s_waitcnt vmcnt(1)
    v_bitop3_b32 v20, v32, v33, s26 bitop3:0x7e
    v_bitop3_b32 v21, v34, v35, s26 bitop3:0x7e
    v_bitop3_b32 v20, v20, v21, s50 bitop3:0xa8
    v_cmp_ne_u32 s[60:61], 0, v20
    v_xor_b32 v46, s49, v32
    v_xor_b32 v47, s49, v33
    v_xor_b32 v48, s49, v34
    v_xor_b32 v49, s49, v35
    v_add_f32 v40, v40, v46
    v_add_f32 v41, v41, v47
    v_add_f32 v42, v42, v48
    v_add_f32 v43, v43, v49
    s_or_b64 s[64:65], s[64:65], s[60:61]
    s_waitcnt vmcnt(0)
    v_bitop3_b32 v20, v36, v37, s26 bitop3:0x7e
    v_bitop3_b32 v21, v38, v39, s26 bitop3:0x7e
    v_bitop3_b32 v20, v20, v21, s50 bitop3:0xa8
    v_cmp_ne_u32 s[62:63], 0, v20
    v_xor_b32 v46, s49, v36
    v_xor_b32 v47, s49, v37
    v_xor_b32 v48, s49, v38
    v_xor_b32 v49, s49, v39
    v_add_f32 v40, v40, v46
    v_add_f32 v41, v41, v47
    v_add_f32 v42, v42, v48
    v_add_f32 v43, v43, v49
    s_or_b64 s[64:65], s[64:65], s[62:63]
    s_cbranch_scc1 L_ypoll
    v_permlane32_swap_b32 v40, v42
    v_permlane32_swap_b32 v41, v43
    v_add_f32 v40, v40, v42
    v_add_f32 v41, v41, v43
    s_nop 1
    v_permlane16_swap_b32 v40, v41
    v_add_f32 v40, v40, v41
    s_nop 1
    v_add_f32_dpp v40, v40, v40 row_ror:8 row_mask:0xf bank_mask:0xf
    s_mov_b64 exec, s[66:67]
    v_cvt_pk_bf16_f32 v40, v40, v40
    global_store_short v45, v40, s[22:23]
    s_cmp_lg_u32 s2, 0
    s_cbranch_scc1 L_done
    s_mov_b64 exec, 1
    v_mov_b32 v20, 0
    v_mov_b32 v21, s26
    global_store_dword v20, v21, s[24:25] sc1
    s_endpgm
L_pv0:
    v_and_b32 v3, 15, v0
    v_lshrrev_b32 v4, 4, v0
    v_mov_b32 v13, 32
    s_mov_b64 exec, 1
    ds_write_b32 v2, v13 offset:24
    s_mov_b64 exec, -1
L_comp:
    s_setprio 2
    s_lshr_b32 s51, s7, 2
    s_lshl_b32 s44, s4, 3
    s_and_b32 s41, s5, 7
    s_add_u32 s44, s44, s41
    v_lshrrev_b32 v6, 2, v0
    v_and_b32 v7, 7, v6
    v_and_b32 v8, 3, v0
    v_lshlrev_b32 v8, 3, v8
    v_lshl_add_u32 v8, v6, 9, v8
    s_lshl_b32 s3, s51, 2
    v_xor_b32 v7, s3, v7
    v_xor_b32 v9, 0, v7
    v_lshl_add_u32 v48, v9, 5, v8
    v_xor_b32 v9, 1, v7
    v_lshl_add_u32 v49, v9, 5, v8
    v_xor_b32 v9, 2, v7
    v_lshl_add_u32 v50, v9, 5, v8
    v_xor_b32 v9, 3, v7
    v_lshl_add_u32 v51, v9, 5, v8
    v_lshrrev_b32 v6, 3, v3
    v_lshlrev_b32 v39, 11, v6
    v_lshl_add_u32 v39, v4, 4, v39
    v_add_u32 v39, 139264, v39
    v_lshrrev_b32 v6, 5, v0
    v_and_b32 v7, 31, v0
    s_lshl_b32 s3, s44, 7
    s_add_u32 s3, s3, 327680
    v_and_b32 v8, 3, v0
    v_lshlrev_b32 v8, 5, v8
    v_lshl_add_u32 v8, v6, 4, v8
    v_add_u32 v228, s3, v8
    s_lshr_b32 s64, s5, 3
    s_add_u32 s65, s64, 32
    s_lshl_b32 s3, s4, 16
    s_lshl_b32 s41, s5, 9
    s_add_u32 s3, s3, s41
    s_lshl_b32 s41, s51, 14
    s_add_u32 s3, s3, s41
    s_add_u32 s3, s3, 524288
    v_lshlrev_b32 v229, 4, v7
    v_lshl_add_u32 v229, v6, 15, v229
    v_add_u32 v229, s3, v229
    s_lshl_b32 s3, s51, 3
    v_add_u32 v230, s3, v2
    s_lshl_b32 s3, s4, 7
    s_add_u32 s3, s3, 344064
    v_lshlrev_b32 v225, 2, v0
    v_add_u32 v225, s3, v225
    s_mov_b32 s50, 0x3db8aa3b
    s_mov_b32 s52, 0
    s_mov_b32 s53, -1
    s_mov_b32 s56, 0x1010101
    s_mov_b32 s57, 0x1010101
    s_mov_b32 s58, 0x2020202
    s_mov_b32 s59, 0x2020202
    s_mov_b32 s60, 0x10101010
    s_mov_b32 s61, 0x10101010
    s_mov_b32 s62, 0x20202020
    s_mov_b32 s63, 0x20202020
    s_mov_b32 s38, 0
    s_mov_b32 s40, 0
    s_mov_b32 s36, 32
    s_cmp_eq_u32 s7, 7
    s_cbranch_scc1 L_pvwait
    s_lshl_b32 s3, s44, 12
    s_add_u32 s3, s3, 4096
    v_lshlrev_b32 v5, 4, v0
    v_add_u32 v5, s3, v5
    v_lshlrev_b32 v226, 12, v6
    v_lshl_add_u32 v226, v7, 5, v226
    v_add_u32 v226, 131072, v226
    v_lshlrev_b32 v227, 11, v6
    v_lshl_add_u32 v227, v7, 4, v227
    v_add_u32 v227, 139264, v227
    s_lshl_b64 s[42:43], 1, s64
    s_mov_b32 s43, s42
    v_lshlrev_b32 v6, 9, v3
    v_xor_b32 v7, v4, v3
    v_xor_b32 v8, 0, v7
    v_lshl_add_u32 v40, v8, 4, v6
    v_xor_b32 v8, 4, v7
    v_lshl_add_u32 v41, v8, 4, v6
    v_xor_b32 v8, 8, v7
    v_lshl_add_u32 v42, v8, 4, v6
    v_xor_b32 v8, 12, v7
    v_lshl_add_u32 v43, v8, 4, v6
    v_and_b32 v6, 1, v0
    v_lshlrev_b32 v38, 12, v6
    v_lshl_add_u32 v38, v4, 5, v38
    v_add_u32 v38, 131072, v38
    v_lshlrev_b32 v37, 9, v6
    v_lshl_add_u32 v37, v4, 4, v37
    v_add_u32 v37, 159744, v37
    v_lshlrev_b32 v36, 3, v0
    v_add_u32 v36, 159744, v36
    s_lshl_b32 s3, s4, 15
    s_lshl_b32 s41, s5, 7
    s_add_u32 s3, s3, s41
    s_add_u32 s3, s3, 4096
    v_lshrrev_b32 v6, 3, v0
    v_and_b32 v224, 7, v0
    v_lshlrev_b32 v224, 4, v224
    v_lshl_add_u32 v224, v6, 12, v224
    v_add_u32 v224, s3, v224
    v_mov_b32 v35, 0xff800000
    s_mov_b32 s46, 0x00030003
    s_mov_b32 s47, 0x00030003
    v_add_u32 v44, 0, v40
    v_add_u32 v45, 0, v41
    v_add_u32 v46, 0, v42
    v_add_u32 v47, 0, v43
    v_mov_b32 v11, 1
    s_cmp_gt_u32 s38, 0
    s_cbranch_scc1 L_ok1
L_sp1:
    ds_read_b32 v10, v2 offset:0
    s_sub_u32 s27, s27, 1
    s_cbranch_scc1 L_done
    s_waitcnt lgkmcnt(0)
    v_readfirstlane_b32 s38, v10
    s_cmp_gt_u32 s38, 0
    s_cbranch_scc0 L_sp1
L_ok1:
    ds_read_b128 v[96:99], v44 offset:0
    ds_read_b128 v[100:103], v44 offset:8192
    ds_read_b128 v[104:107], v45 offset:0
    ds_read_b128 v[108:111], v45 offset:8192
    ds_read_b128 v[112:115], v46 offset:0
    ds_read_b128 v[116:119], v46 offset:8192
    ds_read_b128 v[120:123], v47 offset:0
    ds_read_b128 v[124:127], v47 offset:8192
    ds_read_b128 v[128:131], v44 offset:256
    ds_read_b128 v[132:135], v44 offset:8448
    ds_read_b128 v[136:139], v45 offset:256
    ds_read_b128 v[140:143], v45 offset:8448
    ds_read_b128 v[144:147], v46 offset:256
    ds_read_b128 v[148:151], v46 offset:8448
    ds_read_b128 v[152:155], v47 offset:256
    ds_read_b128 v[156:159], v47 offset:8448
    s_mov_b64 exec, 1
    s_waitcnt lgkmcnt(0)
    ds_write_b32 v2, v11 offset:16
    s_mov_b64 exec, -1
    v_add_u32 v44, 16384, v40
    v_add_u32 v45, 16384, v41
    v_add_u32 v46, 16384, v42
    v_add_u32 v47, 16384, v43
    v_mov_b32 v11, 2
    s_cmp_gt_u32 s38, 1
    s_cbranch_scc1 L_ok2
L_sp2:
    ds_read_b32 v10, v2 offset:0
    s_sub_u32 s27, s27, 1
    s_cbranch_scc1 L_done
    s_waitcnt lgkmcnt(0)
    v_readfirstlane_b32 s38, v10
    s_cmp_gt_u32 s38, 1
    s_cbranch_scc0 L_sp2
L_ok2:
    ds_read_b128 v[160:163], v44 offset:0
    ds_read_b128 v[164:167], v44 offset:8192
    ds_read_b128 v[168:171], v45 offset:0
    ds_read_b128 v[172:175], v45 offset:8192
    ds_read_b128 v[176:179], v46 offset:0
    ds_read_b128 v[180:183], v46 offset:8192
    ds_read_b128 v[184:187], v47 offset:0
    ds_read_b128 v[188:191], v47 offset:8192
    ds_read_b128 v[192:195], v44 offset:256
    ds_read_b128 v[196:199], v44 offset:8448
    ds_read_b128 v[200:203], v45 offset:256
    ds_read_b128 v[204:207], v45 offset:8448
    ds_read_b128 v[208:211], v46 offset:256
    ds_read_b128 v[212:215], v46 offset:8448
    ds_read_b128 v[216:219], v47 offset:256
    ds_read_b128 v[220:223], v47 offset:8448
    s_mov_b64 exec, 1
    s_waitcnt lgkmcnt(0)
    ds_write_b32 v2, v11 offset:16
    s_mov_b64 exec, -1
    s_cmp_gt_u32 s38, 2
    s_cbranch_scc1 L_ok3
L_sp3:
    ds_read_b32 v10, v2 offset:0
    s_sub_u32 s27, s27, 1
    s_cbranch_scc1 L_done
    s_waitcnt lgkmcnt(0)
    v_readfirstlane_b32 s38, v10
    s_cmp_gt_u32 s38, 2
    s_cbranch_scc0 L_sp3
L_ok3:
    s_mov_b32 s39, 8
    s_branch L_qpoll
L_qagain:
    s_sub_u32 s39, s39, 1
    s_cmp_lg_u32 s39, 0
    s_cbranch_scc1 L_qpoll
L_qwide:
    s_mov_b32 s39, 0
    s_cmp_gt_u32 s39, 3
    s_cbranch_scc1 L_ok4
L_sp4:
    ds_read_b32 v28, v2 offset:44
    s_sub_u32 s27, s27, 1
    s_cbranch_scc1 L_done
    s_waitcnt lgkmcnt(0)
    v_readfirstlane_b32 s39, v28
    s_cmp_gt_u32 s39, 3
    s_cbranch_scc0 L_sp4
L_ok4:
    ds_read2_b32 v[28:29], v36 offset1:1
    v_mov_b32 v31, s45
    s_waitcnt lgkmcnt(0)
    v_mov_b32 v30, v29
    v_mov_b32 v29, s45
    global_store_dwordx4 v224, v[28:31], s[24:25] sc1
    s_mov_b32 s39, 0
L_qpoll:
    global_load_dwordx4 v[12:15], v5, s[24:25] offset:0 sc1
    global_load_dwordx4 v[16:19], v5, s[24:25] offset:1024 sc1
    global_load_dwordx4 v[20:23], v5, s[24:25] offset:2048 sc1
    global_load_dwordx4 v[24:27], v5, s[24:25] offset:3072 sc1
    s_sub_u32 s27, s27, 8
    s_cbranch_scc1 L_done
    s_waitcnt vmcnt(0)
    v_bitop3_b32 v13, v13, v15, s45 bitop3:0x7e
    v_bitop3_b32 v17, v17, v19, s45 bitop3:0x7e
    v_bitop3_b32 v21, v21, v23, s45 bitop3:0x7e
    v_bitop3_b32 v25, v25, v27, s45 bitop3:0x7e
    v_or3_b32 v13, v13, v17, v21
    v_or_b32 v13, v13, v25
    v_lshlrev_b32 v17, 3, v13
    v_cmp_ne_u32 vcc, 0, v17
    s_cbranch_vccnz L_qagain
    v_cmp_ne_u32 s[54:55], 0, v13
    s_cmp_gt_i32 s39, 0
    s_cselect_b64 s[66:67], s[54:55], 0
    s_cmp_lg_u64 s[66:67], 0
    s_cbranch_scc1 L_qwide
    ds_write2_b32 v36, v12, v14 offset0:0 offset1:1
    ds_write2_b32 v36, v16, v18 offset0:128 offset1:129
    s_or_b32 s54, s54, s55
    v_mov_b32 v17, s54
    s_mov_b64 exec, 1
    ds_write_b32 v2, v17 offset:52
    s_mov_b64 exec, -1
    v_add_u32 v36, 1024, v36
    ds_write2_b32 v36, v20, v22 offset0:0 offset1:1
    ds_write2_b32 v36, v24, v26 offset0:128 offset1:129
    s_waitcnt lgkmcnt(0)
    ds_read_b128 v[64:67], v37 offset:0
    ds_read_b128 v[68:71], v37 offset:64
    ds_read_b128 v[72:75], v37 offset:128
    ds_read_b128 v[76:79], v37 offset:192
    ds_read_b128 v[80:83], v37 offset:256
    ds_read_b128 v[84:87], v37 offset:320
    ds_read_b128 v[88:91], v37 offset:384
    ds_read_b128 v[92:95], v37 offset:448
    s_mov_b32 s36, 2
    s_mov_b32 s40, 32768
    s_mov_b32 s39, 32
    s_waitcnt lgkmcnt(0)
    v_mfma_f32_16x16x32_bf16 v[24:27], v[96:99], v[64:67], 0
    v_mfma_f32_16x16x32_bf16 v[28:31], v[100:103], v[64:67], 0
    v_mfma_f32_16x16x32_bf16 v[24:27], v[104:107], v[68:71], v[24:27]
    v_mfma_f32_16x16x32_bf16 v[28:31], v[108:111], v[68:71], v[28:31]
    v_mfma_f32_16x16x32_bf16 v[24:27], v[112:115], v[72:75], v[24:27]
    v_mfma_f32_16x16x32_bf16 v[28:31], v[116:119], v[72:75], v[28:31]
    v_mfma_f32_16x16x32_bf16 v[24:27], v[120:123], v[76:79], v[24:27]
    v_mfma_f32_16x16x32_bf16 v[28:31], v[124:127], v[76:79], v[28:31]
    v_mfma_f32_16x16x32_bf16 v[24:27], v[128:131], v[80:83], v[24:27]
    v_mfma_f32_16x16x32_bf16 v[28:31], v[132:135], v[80:83], v[28:31]
    v_mfma_f32_16x16x32_bf16 v[24:27], v[136:139], v[84:87], v[24:27]
    v_mfma_f32_16x16x32_bf16 v[28:31], v[140:143], v[84:87], v[28:31]
    v_mfma_f32_16x16x32_bf16 v[24:27], v[144:147], v[88:91], v[24:27]
    v_mfma_f32_16x16x32_bf16 v[28:31], v[148:151], v[88:91], v[28:31]
    v_mfma_f32_16x16x32_bf16 v[24:27], v[152:155], v[92:95], v[24:27]
    v_mfma_f32_16x16x32_bf16 v[28:31], v[156:159], v[92:95], v[28:31]
    s_mov_b64 exec, s[46:47]
    s_nop 7
    ds_write_b128 v38, v[24:27]
    ds_write_b128 v38, v[28:31] offset:16
    s_mov_b64 exec, -1
    v_max3_f32 v35, v35, v24, v25
    v_max3_f32 v35, v35, v26, v27
    v_max3_f32 v35, v35, v28, v29
    v_max3_f32 v35, v35, v30, v31
    v_add_u32 v38, 128, v38
    v_mfma_f32_16x16x32_bf16 v[24:27], v[160:163], v[64:67], 0
    v_mfma_f32_16x16x32_bf16 v[28:31], v[164:167], v[64:67], 0
    v_mfma_f32_16x16x32_bf16 v[24:27], v[168:171], v[68:71], v[24:27]
    v_mfma_f32_16x16x32_bf16 v[28:31], v[172:175], v[68:71], v[28:31]
    v_mfma_f32_16x16x32_bf16 v[24:27], v[176:179], v[72:75], v[24:27]
    v_mfma_f32_16x16x32_bf16 v[28:31], v[180:183], v[72:75], v[28:31]
    v_mfma_f32_16x16x32_bf16 v[24:27], v[184:187], v[76:79], v[24:27]
    v_mfma_f32_16x16x32_bf16 v[28:31], v[188:191], v[76:79], v[28:31]
    v_mfma_f32_16x16x32_bf16 v[24:27], v[192:195], v[80:83], v[24:27]
    v_mfma_f32_16x16x32_bf16 v[28:31], v[196:199], v[80:83], v[28:31]
    v_mfma_f32_16x16x32_bf16 v[24:27], v[200:203], v[84:87], v[24:27]
    v_mfma_f32_16x16x32_bf16 v[28:31], v[204:207], v[84:87], v[28:31]
    v_mfma_f32_16x16x32_bf16 v[24:27], v[208:211], v[88:91], v[24:27]
    v_mfma_f32_16x16x32_bf16 v[28:31], v[212:215], v[88:91], v[28:31]
    v_mfma_f32_16x16x32_bf16 v[24:27], v[216:219], v[92:95], v[24:27]
    v_mfma_f32_16x16x32_bf16 v[28:31], v[220:223], v[92:95], v[28:31]
    s_mov_b64 exec, s[46:47]
    s_nop 7
    ds_write_b128 v38, v[24:27]
    ds_write_b128 v38, v[28:31] offset:16
    s_mov_b64 exec, -1
    v_max3_f32 v35, v35, v24, v25
    v_max3_f32 v35, v35, v26, v27
    v_max3_f32 v35, v35, v28, v29
    v_max3_f32 v35, v35, v30, v31
    v_add_u32 v38, 128, v38
L_kloop:
    s_cmp_gt_u32 s38, s36
    s_cbranch_scc1 L_ok5
L_sp5:
    ds_read_b32 v12, v2 offset:0
    s_sub_u32 s27, s27, 1
    s_cbranch_scc1 L_done
    s_waitcnt lgkmcnt(0)
    v_readfirstlane_b32 s38, v12
    s_cmp_gt_u32 s38, s36
    s_cbranch_scc0 L_sp5
L_ok5:
    v_add_u32 v44, s40, v40
    v_add_u32 v45, s40, v41
    v_add_u32 v46, s40, v42
    v_add_u32 v47, s40, v43
    ds_read_b128 v[96:99], v44 offset:0
    ds_read_b128 v[100:103], v44 offset:8192
    ds_read_b128 v[104:107], v45 offset:0
    ds_read_b128 v[108:111], v45 offset:8192
    ds_read_b128 v[112:115], v46 offset:0
    ds_read_b128 v[116:119], v46 offset:8192
    ds_read_b128 v[120:123], v47 offset:0
    ds_read_b128 v[124:127], v47 offset:8192
    ds_read_b128 v[128:131], v44 offset:256
    ds_read_b128 v[132:135], v44 offset:8448
    ds_read_b128 v[136:139], v45 offset:256
    ds_read_b128 v[140:143], v45 offset:8448
    ds_read_b128 v[144:147], v46 offset:256
    ds_read_b128 v[148:151], v46 offset:8448
    ds_read_b128 v[152:155], v47 offset:256
    ds_read_b128 v[156:159], v47 offset:8448
    s_add_u32 s36, s36, 1
    v_mov_b32 v13, s36
    s_waitcnt lgkmcnt(14)
    v_mfma_f32_16x16x32_bf16 v[24:27], v[96:99], v[64:67], 0
    v_mfma_f32_16x16x32_bf16 v[28:31], v[100:103], v[64:67], 0
    s_waitcnt lgkmcnt(12)
    v_mfma_f32_16x16x32_bf16 v[24:27], v[104:107], v[68:71], v[24:27]
    v_mfma_f32_16x16x32_bf16 v[28:31], v[108:111], v[68:71], v[28:31]
    s_waitcnt lgkmcnt(10)
    v_mfma_f32_16x16x32_bf16 v[24:27], v[112:115], v[72:75], v[24:27]
    v_mfma_f32_16x16x32_bf16 v[28:31], v[116:119], v[72:75], v[28:31]
    s_waitcnt lgkmcnt(8)
    v_mfma_f32_16x16x32_bf16 v[24:27], v[120:123], v[76:79], v[24:27]
    v_mfma_f32_16x16x32_bf16 v[28:31], v[124:127], v[76:79], v[28:31]
    s_waitcnt lgkmcnt(6)
    v_mfma_f32_16x16x32_bf16 v[24:27], v[128:131], v[80:83], v[24:27]
    v_mfma_f32_16x16x32_bf16 v[28:31], v[132:135], v[80:83], v[28:31]
    s_waitcnt lgkmcnt(4)
    v_mfma_f32_16x16x32_bf16 v[24:27], v[136:139], v[84:87], v[24:27]
    v_mfma_f32_16x16x32_bf16 v[28:31], v[140:143], v[84:87], v[28:31]
    s_waitcnt lgkmcnt(2)
    v_mfma_f32_16x16x32_bf16 v[24:27], v[144:147], v[88:91], v[24:27]
    v_mfma_f32_16x16x32_bf16 v[28:31], v[148:151], v[88:91], v[28:31]
    s_waitcnt lgkmcnt(0)
    v_mfma_f32_16x16x32_bf16 v[24:27], v[152:155], v[92:95], v[24:27]
    v_mfma_f32_16x16x32_bf16 v[28:31], v[156:159], v[92:95], v[28:31]
    s_mov_b64 exec, 1
    ds_write_b32 v2, v13 offset:16
    s_add_u32 s40, s40, 0x4000
    s_and_b32 s40, s40, 0x1ffff
    s_mov_b64 exec, s[46:47]
    s_nop 3
    ds_write_b128 v38, v[24:27]
    ds_write_b128 v38, v[28:31] offset:16
    s_mov_b64 exec, -1
    v_max3_f32 v35, v35, v24, v25
    v_max3_f32 v35, v35, v26, v27
    v_max3_f32 v35, v35, v28, v29
    v_max3_f32 v35, v35, v30, v31
    v_add_u32 v38, 128, v38
    s_cmp_lt_u32 s36, s39
    s_cbranch_scc1 L_kloop
    ds_read_b128 v[96:99], v226 offset:0
    ds_read_b128 v[100:103], v226 offset:16
    ds_read_b128 v[104:107], v226 offset:1024
    ds_read_b128 v[108:111], v226 offset:1040
    ds_read_b128 v[112:115], v226 offset:2048
    ds_read_b128 v[116:119], v226 offset:2064
    ds_read_b128 v[120:123], v226 offset:3072
    ds_read_b128 v[124:127], v226 offset:3088
    v_mov_b32 v12, v35
    s_nop 1
    v_permlane32_swap_b32 v35, v12
    v_max_f32 v35, v35, v12
    v_mov_b32 v12, v35
    s_nop 1
    v_permlane16_swap_b32 v35, v12
    v_max_f32 v35, v35, v12
    s_nop 0
    v_readlane_b32 s48, v35, 0
    v_readlane_b32 s49, v35, 1
    v_subrev_u32 v38, 4096, v38
    v_mov_b32 v35, 0xff800000
    v_mov_b32 v34, 0
    v_mov_b32 v32, s48
    v_mov_b32 v12, s49
    v_cndmask_b32 v32, v32, v12, s[52:53]
    v_mul_f32 v33, s50, v32
    v_sub_f32 v33, 0, v33
    s_waitcnt lgkmcnt(6)
    v_fma_f32 v96, v96, s50, v33
    v_fma_f32 v97, v97, s50, v33
    v_fma_f32 v98, v98, s50, v33
    v_fma_f32 v99, v99, s50, v33
    v_fma_f32 v100, v100, s50, v33
    v_fma_f32 v101, v101, s50, v33
    v_fma_f32 v102, v102, s50, v33
    v_fma_f32 v103, v103, s50, v33
    v_exp_f32 v96, v96
    v_exp_f32 v97, v97
    v_exp_f32 v98, v98
    v_exp_f32 v99, v99
    v_exp_f32 v100, v100
    v_exp_f32 v101, v101
    v_exp_f32 v102, v102
    v_exp_f32 v103, v103
    s_nop 0
    v_cvt_pk_bf16_f32 v16, v96, v97
    v_cvt_pk_bf16_f32 v17, v98, v99
    v_cvt_pk_bf16_f32 v18, v100, v101
    v_cvt_pk_bf16_f32 v19, v102, v103
    ds_write_b128 v227, v[16:19] offset:0
    v_add_f32 v96, v96, v97
    v_add_f32 v98, v98, v99
    v_add_f32 v100, v100, v101
    v_add_f32 v102, v102, v103
    v_add_f32 v96, v96, v98
    v_add_f32 v100, v100, v102
    v_add_f32 v96, v96, v100
    v_add_f32 v34, v34, v96
    s_waitcnt lgkmcnt(5)
    v_fma_f32 v104, v104, s50, v33
    v_fma_f32 v105, v105, s50, v33
    v_fma_f32 v106, v106, s50, v33
    v_fma_f32 v107, v107, s50, v33
    v_fma_f32 v108, v108, s50, v33
    v_fma_f32 v109, v109, s50, v33
    v_fma_f32 v110, v110, s50, v33
    v_fma_f32 v111, v111, s50, v33
    v_exp_f32 v104, v104
    v_exp_f32 v105, v105
    v_exp_f32 v106, v106
    v_exp_f32 v107, v107
    v_exp_f32 v108, v108
    v_exp_f32 v109, v109
    v_exp_f32 v110, v110
    v_exp_f32 v111, v111
    s_nop 0
    v_cvt_pk_bf16_f32 v16, v104, v105
    v_cvt_pk_bf16_f32 v17, v106, v107
    v_cvt_pk_bf16_f32 v18, v108, v109
    v_cvt_pk_bf16_f32 v19, v110, v111
    ds_write_b128 v227, v[16:19] offset:512
    v_add_f32 v104, v104, v105
    v_add_f32 v106, v106, v107
    v_add_f32 v108, v108, v109
    v_add_f32 v110, v110, v111
    v_add_f32 v104, v104, v106
    v_add_f32 v108, v108, v110
    v_add_f32 v104, v104, v108
    v_add_f32 v34, v34, v104
    s_waitcnt lgkmcnt(4)
    v_fma_f32 v112, v112, s50, v33
    v_fma_f32 v113, v113, s50, v33
    v_fma_f32 v114, v114, s50, v33
    v_fma_f32 v115, v115, s50, v33
    v_fma_f32 v116, v116, s50, v33
    v_fma_f32 v117, v117, s50, v33
    v_fma_f32 v118, v118, s50, v33
    v_fma_f32 v119, v119, s50, v33
    v_exp_f32 v112, v112
    v_exp_f32 v113, v113
    v_exp_f32 v114, v114
    v_exp_f32 v115, v115
    v_exp_f32 v116, v116
    v_exp_f32 v117, v117
    v_exp_f32 v118, v118
    v_exp_f32 v119, v119
    s_nop 0
    v_cvt_pk_bf16_f32 v16, v112, v113
    v_cvt_pk_bf16_f32 v17, v114, v115
    v_cvt_pk_bf16_f32 v18, v116, v117
    v_cvt_pk_bf16_f32 v19, v118, v119
    ds_write_b128 v227, v[16:19] offset:1024
    v_add_f32 v112, v112, v113
    v_add_f32 v114, v114, v115
    v_add_f32 v116, v116, v117
    v_add_f32 v118, v118, v119
    v_add_f32 v112, v112, v114
    v_add_f32 v116, v116, v118
    v_add_f32 v112, v112, v116
    v_add_f32 v34, v34, v112
    s_waitcnt lgkmcnt(3)
    v_fma_f32 v120, v120, s50, v33
    v_fma_f32 v121, v121, s50, v33
    v_fma_f32 v122, v122, s50, v33
    v_fma_f32 v123, v123, s50, v33
    v_fma_f32 v124, v124, s50, v33
    v_fma_f32 v125, v125, s50, v33
    v_fma_f32 v126, v126, s50, v33
    v_fma_f32 v127, v127, s50, v33
    v_exp_f32 v120, v120
    v_exp_f32 v121, v121
    v_exp_f32 v122, v122
    v_exp_f32 v123, v123
    v_exp_f32 v124, v124
    v_exp_f32 v125, v125
    v_exp_f32 v126, v126
    v_exp_f32 v127, v127
    s_nop 0
    v_cvt_pk_bf16_f32 v16, v120, v121
    v_cvt_pk_bf16_f32 v17, v122, v123
    v_cvt_pk_bf16_f32 v18, v124, v125
    v_cvt_pk_bf16_f32 v19, v126, v127
    ds_write_b128 v227, v[16:19] offset:1536
    v_add_f32 v120, v120, v121
    v_add_f32 v122, v122, v123
    v_add_f32 v124, v124, v125
    v_add_f32 v126, v126, v127
    v_add_f32 v120, v120, v122
    v_add_f32 v124, v124, v126
    v_add_f32 v120, v120, v124
    v_add_f32 v34, v34, v120
    s_mov_b64 exec, 1
    ds_write_b32 v2, v13 offset:48
    s_mov_b64 exec, -1
    s_nop 1
    v_add_f32_dpp v34, v34, v34 row_ror:8 row_mask:0xf bank_mask:0xf
    s_nop 1
    v_add_f32_dpp v34, v34, v34 row_ror:4 row_mask:0xf bank_mask:0xf
    s_nop 1
    v_add_f32_dpp v34, v34, v34 row_ror:2 row_mask:0xf bank_mask:0xf
    s_nop 1
    v_add_f32_dpp v34, v34, v34 row_ror:1 row_mask:0xf bank_mask:0xf
    v_mov_b32 v12, v34
    s_nop 1
    v_permlane16_swap_b32 v34, v12
    v_add_f32 v34, v34, v12
    v_mov_b32 v16, v32
    v_mov_b32 v17, s26
    v_mov_b32 v18, v34
    v_mov_b32 v19, s26
    s_mov_b64 exec, s[42:43]
    s_cmp_eq_u32 s54, 0
    s_cbranch_scc0 L_mlg
    global_store_dwordx4 v228, v[16:19], s[24:25]
    s_branch L_mld
L_mlg:
    global_store_dwordx4 v228, v[16:19], s[24:25] sc1
L_mld:
    s_mov_b64 exec, -1
L_pv:
    v_mov_b32 v64, 0
    v_mov_b32 v65, 0
    v_mov_b32 v66, 0
    v_mov_b32 v67, 0
    v_mov_b32 v68, 0
    v_mov_b32 v69, 0
    v_mov_b32 v70, 0
    v_mov_b32 v71, 0
    v_mov_b32 v72, 0
    v_mov_b32 v73, 0
    v_mov_b32 v74, 0
    v_mov_b32 v75, 0
    v_mov_b32 v76, 0
    v_mov_b32 v77, 0
    v_mov_b32 v78, 0
    v_mov_b32 v79, 0
    v_mov_b32 v20, 0
    v_mov_b32 v21, 0
    v_mov_b32 v22, 0
    v_mov_b32 v23, 0
    v_mov_b32 v24, 0
    v_mov_b32 v25, 0
    v_mov_b32 v26, 0
    v_mov_b32 v27, 0
    s_lshl_b32 s3, s36, 25
    s_and_b32 s3, s3, 0x80000000
    s_xor_b32 s3, s3, s26
    v_mov_b32 v233, s3
    v_mov_b32 v235, s3
    s_add_u32 s39, s36, 10
L_vloop:
    s_mov_b64 exec, s[56:57]
    ds_read_b128 v[64:67], v39
    s_mov_b64 exec, s[58:59]
    ds_read_b128 v[68:71], v39
    s_mov_b64 exec, s[60:61]
    ds_read_b128 v[72:75], v39
    s_mov_b64 exec, s[62:63]
    ds_read_b128 v[76:79], v39
    s_mov_b64 exec, -1
    v_add_u32 v39, 64, v39
    v_add_u32 v4, s40, v48
    v_add_u32 v5, s40, v49
    v_add_u32 v6, s40, v50
    v_add_u32 v7, s40, v51
    s_cmp_gt_u32 s38, s36
    s_cbranch_scc1 L_ok6
L_sp6:
    ds_read_b32 v12, v2 offset:0
    s_sub_u32 s27, s27, 1
    s_cbranch_scc1 L_done
    s_waitcnt lgkmcnt(0)
    v_readfirstlane_b32 s38, v12
    s_cmp_gt_u32 s38, s36
    s_cbranch_scc0 L_sp6
L_ok6:
    ds_read_b64_tr_b16 v[96:97], v4 offset:0
    ds_read_b64_tr_b16 v[98:99], v4 offset:8192
    ds_read_b64_tr_b16 v[100:101], v4 offset:256
    ds_read_b64_tr_b16 v[102:103], v4 offset:8448
    ds_read_b64_tr_b16 v[104:105], v5 offset:0
    ds_read_b64_tr_b16 v[106:107], v5 offset:8192
    ds_read_b64_tr_b16 v[108:109], v5 offset:256
    ds_read_b64_tr_b16 v[110:111], v5 offset:8448
    ds_read_b64_tr_b16 v[112:113], v6 offset:0
    ds_read_b64_tr_b16 v[114:115], v6 offset:8192
    ds_read_b64_tr_b16 v[116:117], v6 offset:256
    ds_read_b64_tr_b16 v[118:119], v6 offset:8448
    s_add_u32 s36, s36, 1
    v_mov_b32 v13, s36
    s_add_u32 s40, s40, 0x4000
    s_and_b32 s40, s40, 0x1ffff
    ds_read_b64_tr_b16 v[120:121], v7 offset:0
    ds_read_b64_tr_b16 v[122:123], v7 offset:8192
    ds_read_b64_tr_b16 v[124:125], v7 offset:256
    ds_read_b64_tr_b16 v[126:127], v7 offset:8448
    s_waitcnt lgkmcnt(12)
    v_mfma_f32_16x16x32_bf16 v[20:23], v[64:67], v[96:99], v[20:23]
    v_mfma_f32_16x16x32_bf16 v[24:27], v[64:67], v[100:103], v[24:27]
    s_waitcnt lgkmcnt(8)
    v_mfma_f32_16x16x32_bf16 v[20:23], v[68:71], v[104:107], v[20:23]
    v_mfma_f32_16x16x32_bf16 v[24:27], v[68:71], v[108:111], v[24:27]
    s_waitcnt lgkmcnt(4)
    v_mfma_f32_16x16x32_bf16 v[20:23], v[72:75], v[112:115], v[20:23]
    v_mfma_f32_16x16x32_bf16 v[24:27], v[72:75], v[116:119], v[24:27]
    s_waitcnt lgkmcnt(0)
    v_mfma_f32_16x16x32_bf16 v[20:23], v[76:79], v[120:123], v[20:23]
    v_mfma_f32_16x16x32_bf16 v[24:27], v[76:79], v[124:127], v[24:27]
    s_mov_b64 exec, 1
    ds_write_b32 v230, v13 offset:16
    s_mov_b64 exec, -1
    s_cmp_lt_u32 s36, s39
    s_cbranch_scc1 L_vloop
    s_and_b32 s41, s36, 63
    s_cbranch_scc1 L_mlpoll
    s_cmp_eq_u32 s54, 0
    s_nop 0
    v_mul_f32 v20, v231, v20
    v_mul_f32 v21, v231, v21
    v_mul_f32 v24, v231, v24
    v_mul_f32 v25, v231, v25
    v_cvt_pk_bf16_f32 v232, v20, v21
    v_cvt_pk_bf16_f32 v234, v24, v25
    s_cbranch_scc0 L_opubg
    global_store_dwordx4 v229, v[232:235], s[24:25]
    s_branch L_opubd
L_opubg:
    global_store_dwordx4 v229, v[232:235], s[24:25] sc1
L_opubd:
    s_cmp_eq_u32 s36, 128
    s_cbranch_scc1 L_done
    v_subrev_u32 v39, 2048, v39
    v_add_u32 v228, 0x2000, v228
    s_cmp_eq_u32 s7, 7
    s_cbranch_scc1 L_pvnext
    ds_read_b128 v[64:67], v37 offset:1024
    ds_read_b128 v[68:71], v37 offset:1088
    ds_read_b128 v[72:75], v37 offset:1152
    ds_read_b128 v[76:79], v37 offset:1216
    ds_read_b128 v[80:83], v37 offset:1280
    ds_read_b128 v[84:87], v37 offset:1344
    ds_read_b128 v[88:91], v37 offset:1408
    ds_read_b128 v[92:95], v37 offset:1472
    s_mov_b32 s39, 96
    s_branch L_kloop
L_pvnext:
    s_movk_i32 s36, 96
    v_mov_b32 v13, s36
    s_mov_b64 exec, 1
    ds_write_b32 v2, v13 offset:24
    s_mov_b64 exec, -1
L_pvwait:
    s_sub_u32 s39, s36, 4
    s_cmp_gt_u32 s38, s39
    s_cbranch_scc1 L_ok7
L_sp7:
    s_sleep 16
    ds_read_b32 v12, v2 offset:0
    s_sub_u32 s27, s27, 1
    s_cbranch_scc1 L_done
    s_waitcnt lgkmcnt(0)
    v_readfirstlane_b32 s38, v12
    s_cmp_gt_u32 s38, s39
    s_cbranch_scc0 L_sp7
L_ok7:
    s_sub_u32 s39, s36, 1
    s_mov_b32 s41, 0
    s_cmp_gt_u32 s41, s39
    s_cbranch_scc1 L_ok8
L_sp8:
    s_sleep 1
    ds_read_b32 v12, v2 offset:48
    s_sub_u32 s27, s27, 1
    s_cbranch_scc1 L_done
    s_waitcnt lgkmcnt(0)
    v_readfirstlane_b32 s41, v12
    s_cmp_gt_u32 s41, s39
    s_cbranch_scc0 L_sp8
L_ok8:
    ds_read_b32 v12, v2 offset:28
    ds_read_b32 v13, v2 offset:52
    s_waitcnt lgkmcnt(0)
    v_readfirstlane_b32 s26, v12
    v_readfirstlane_b32 s54, v13
    s_branch L_pv
L_mlpoll:
    global_load_dwordx4 v[16:19], v228, s[24:25] sc1
    s_sub_u32 s27, s27, 8
    s_cbranch_scc1 L_done
    s_waitcnt vmcnt(0)
    v_bitop3_b32 v17, v17, v19, s26 bitop3:0x7e
    v_cmp_ne_u32 vcc, 0, v17
    s_cbranch_vccnz L_mlpoll
    s_cmp_lt_u32 s36, 64
    s_cbranch_scc1 L_fok
    s_mov_b64 exec, 0xfffffff
L_fpoll:
    global_load_dword v17, v225, s[24:25] sc1
    s_sub_u32 s27, s27, 8
    s_cbranch_scc1 L_done
    s_waitcnt vmcnt(0)
    v_cmp_ne_u32 vcc, s26, v17
    s_cbranch_vccnz L_fpoll
    s_mov_b64 exec, -1
L_fok:
    v_max_f32_dpp v17, v16, v16 quad_perm:[1,0,3,2] row_mask:0xf bank_mask:0xf
    s_nop 1
    v_max_f32_dpp v17, v17, v17 quad_perm:[2,3,0,1] row_mask:0xf bank_mask:0xf
    v_sub_f32 v16, v16, v17
    v_mul_f32 v16, s50, v16
    v_exp_f32 v16, v16
    s_nop 0
    v_mul_f32 v18, v18, v16
    s_nop 1
    v_add_f32_dpp v18, v18, v18 quad_perm:[1,0,3,2] row_mask:0xf bank_mask:0xf
    s_nop 1
    v_add_f32_dpp v18, v18, v18 quad_perm:[2,3,0,1] row_mask:0xf bank_mask:0xf
    v_rcp_f32 v18, v18
    s_nop 0
    v_mul_f32 v18, v18, v16
    s_nop 0
    v_readlane_b32 s48, v18, s64
    v_readlane_b32 s49, v18, s65
    s_add_u32 s39, s39, 22
    s_nop 0
    v_mov_b32 v231, s48
    v_mov_b32 v17, s49
    v_cndmask_b32 v231, v231, v17, s[52:53]
    s_branch L_vloop
L_tail0:
L_tail1:
    v_and_b32 v3, 15, v0
    v_lshrrev_b32 v4, 4, v0
L_tail:
    s_sub_u32 s48, s7, 2
    s_cmp_ge_u32 s5, 28
    s_cbranch_scc1 L_done
    s_lshl_b32 s45, s4, 2
    s_and_b32 s41, s5, 3
    s_add_u32 s45, s45, s41
    s_and_b32 s46, s5, 28
    s_add_u32 s46, s46, s48
    v_lshrrev_b32 v5, 2, v3
    v_and_b32 v6, 3, v0
    v_lshlrev_b32 v6, 3, v6
    v_lshl_add_u32 v6, v5, 10, v6
    v_and_b32 v7, 1, v4
    v_lshl_add_u32 v7, v4, 1, v7
    v_lshl_add_u32 v6, v7, 7, v6
    v_xor_b32 v5, s48, v5
    v_lshl_add_u32 v8, v5, 5, v6
    v_xor_b32 v9, 128, v8
    v_add_u32 v8, 143360, v8
    v_add_u32 v9, 143360, v9
    s_lshl_b32 s3, s45, 14
    s_lshl_b32 s41, s48, 12
    s_add_u32 s3, s3, s41
    s_add_u32 s3, s3, 524288
    v_lshlrev_b32 v11, 4, v0
    v_add_u32 v11, s3, v11
    v_lshrrev_b32 v6, 5, v0
    v_mul_u32_u24 v100, 272, v6
    v_and_b32 v6, 31, v0
    v_lshl_add_u32 v100, v6, 3, v100
    s_mul_i32 s41, s48, 2176
    s_add_u32 s41, s41, 143360
    v_add_u32 v100, s41, v100
    v_add_u32 v101, 544, v100
    v_add_u32 v102, 1088, v100
    v_add_u32 v103, 1632, v100
    v_mul_u32_u24 v16, 272, v3
    v_lshl_add_u32 v16, v4, 4, v16
    v_add_u32 v16, 143360, v16
    v_mov_b32 v17, 1
    s_lshl_b32 s3, s46, 14
    s_lshl_b32 s41, s45, 7
    s_add_u32 s3, s3, s41
    s_add_u32 s3, s3, 1048576
    v_lshrrev_b32 v6, 3, v0
    v_lshlrev_b32 v6, 12, v6
    v_and_b32 v7, 7, v0
    v_lshl_add_u32 v6, v7, 4, v6
    v_add_u32 v10, s3, v6
    s_movk_i32 s50, 0xf000
    s_load_dwordx2 s[22:23], s[0:1], 80
    s_mul_i32 s51, s4, 14
    s_lshr_b32 s3, s5, 1
    s_add_u32 s51, s51, s3
    s_lshl_b32 s3, s51, 12
    s_lshl_b32 s41, s48, 5
    s_add_u32 s3, s3, s41
    s_add_u32 s3, s3, 1507328
    v_lshrrev_b32 v6, 1, v0
    v_lshlrev_b32 v6, 7, v6
    v_and_b32 v7, 1, v0
    v_lshl_add_u32 v18, v7, 4, v6
    v_add_u32 v18, s3, v18
    s_bfe_u32 s3, s51, 0x10001
    s_mul_i32 s3, s3, 7168
    s_add_u32 s3, s3, 896
    s_lshr_b32 s41, s51, 2
    s_lshl_b32 s41, s41, 5
    s_add_u32 s3, s3, s41
    s_and_b32 s41, s51, 1
    s_lshl_b32 s41, s41, 4
    s_add_u32 s3, s3, s41
    s_lshl_b32 s41, s48, 2
    s_add_u32 s3, s3, s41
    v_mul_u32_u24 v19, 1792, v4
    v_lshl_add_u32 v19, v7, 1, v19
    v_add_u32 v19, s3, v19
    s_movk_i32 s51, 0xfff
    s_mov_b32 s68, 0x00030003
    s_mov_b32 s69, s68
    s_mov_b32 s36, 0
    s_cmp_gt_u32 s36, 41
    s_cbranch_scc1 L_ok9
L_sp9:
    s_sleep 32
    ds_read_b32 v20, v2 offset:0
    s_sub_u32 s27, s27, 1
    s_cbranch_scc1 L_done
    s_waitcnt lgkmcnt(0)
    v_readfirstlane_b32 s36, v20
    s_cmp_gt_u32 s36, 41
    s_cbranch_scc0 L_sp9
L_ok9:
    ds_read_b32 v12, v2 offset:28
    s_mov_b32 s42, 0
    s_mov_b32 s43, 0
    s_mov_b32 s47, 3
    s_waitcnt lgkmcnt(0)
    v_readfirstlane_b32 s26, v12
    v_and_b32 v12, 0xfff, v12
    v_xor_b32 v23, 0x800, v12
    s_branch L_it
L_itA:
    s_waitcnt lgkmcnt(0)
    s_mov_b64 exec, 1
    ds_add_u32 v2, v17 offset:32
    s_mov_b64 exec, -1
    s_cmp_gt_u32 s36, 70
    s_cbranch_scc1 L_ok10
L_sp10:
    s_sleep 8
    ds_read_b32 v20, v2 offset:0
    s_sub_u32 s27, s27, 1
    s_cbranch_scc1 L_done
    s_waitcnt lgkmcnt(0)
    v_readfirstlane_b32 s36, v20
    s_cmp_gt_u32 s36, 70
    s_cbranch_scc0 L_sp10
L_ok10:
    s_mov_b32 s38, 0
    s_cmp_gt_u32 s38, 3
    s_cbranch_scc1 L_ok11
L_sp11:
    ds_read_b32 v20, v2 offset:32
    s_sub_u32 s27, s27, 1
    s_cbranch_scc1 L_done
    s_waitcnt lgkmcnt(0)
    v_readfirstlane_b32 s38, v20
    s_cmp_gt_u32 s38, 3
    s_cbranch_scc0 L_sp11
L_ok11:
    s_branch L_proj
L_cntA:
    s_mov_b64 exec, 1
    ds_add_u32 v2, v17 offset:36
    s_mov_b64 exec, -1
    s_mov_b32 s38, 0
    s_cmp_gt_u32 s38, 3
    s_cbranch_scc1 L_ok12
L_sp12:
    s_sleep 2
    ds_read_b32 v20, v2 offset:36
    s_sub_u32 s27, s27, 1
    s_cbranch_scc1 L_done
    s_waitcnt lgkmcnt(0)
    v_readfirstlane_b32 s38, v20
    s_cmp_gt_u32 s38, 3
    s_cbranch_scc0 L_sp12
L_ok12:
    s_cmp_lg_u32 s48, 0
    s_cbranch_scc1 L_frag
    ds_read_b32 v20, v2 offset:52
    s_lshl_b32 s3, s4, 5
    s_add_u32 s3, s3, s5
    s_lshl_b32 s3, s3, 2
    s_add_u32 s3, s3, 344064
    v_mov_b32 v21, s3
    v_mov_b32 v22, s26
    s_waitcnt lgkmcnt(0)
    v_readfirstlane_b32 s3, v20
    s_mov_b64 exec, 1
    s_cmp_lg_u32 s3, 0
    s_cbranch_scc1 L_flg
    global_store_dword v21, v22, s[24:25]
    s_mov_b64 exec, -1
    s_branch L_frag
L_flg:
    global_store_dword v21, v22, s[24:25] sc1
    s_mov_b64 exec, -1
    s_branch L_frag
L_itA2:
    s_mov_b64 exec, 1
    ds_add_u32 v2, v17 offset:32
    s_mov_b64 exec, -1
    s_xor_b32 s26, s26, 0x80000000
    v_subrev_u32 v8, 143360, v8
    v_subrev_u32 v9, 143360, v9
    s_movk_i32 s42, 128
    s_movk_i32 s43, 129
    s_mov_b32 s47, 7
    s_cmp_gt_u32 s36, 118
    s_cbranch_scc1 L_ok13
L_sp13:
    s_sleep 32
    ds_read_b32 v20, v2 offset:0
    s_sub_u32 s27, s27, 1
    s_cbranch_scc1 L_done
    s_waitcnt lgkmcnt(0)
    v_readfirstlane_b32 s36, v20
    s_cmp_gt_u32 s36, 118
    s_cbranch_scc0 L_sp13
L_ok13:
    s_mov_b32 s38, 0
    s_cmp_gt_u32 s38, 7
    s_cbranch_scc1 L_ok14
L_sp14:
    ds_read_b32 v20, v2 offset:32
    s_sub_u32 s27, s27, 1
    s_cbranch_scc1 L_done
    s_waitcnt lgkmcnt(0)
    v_readfirstlane_b32 s38, v20
    s_cmp_gt_u32 s38, 7
    s_cbranch_scc0 L_sp14
L_ok14:
    s_cmp_gt_u32 s36, 125
    s_cbranch_scc1 L_ok15
L_sp15:
    s_sleep 2
    ds_read_b32 v20, v2 offset:0
    s_sub_u32 s27, s27, 1
    s_cbranch_scc1 L_done
    s_waitcnt lgkmcnt(0)
    v_readfirstlane_b32 s36, v20
    s_cmp_gt_u32 s36, 125
    s_cbranch_scc0 L_sp15
L_ok15:
    s_cmp_gt_u32 s36, 126
    s_cbranch_scc1 L_ok16
L_sp16:
    s_sleep 1
    ds_read_b32 v20, v2 offset:0
    s_sub_u32 s27, s27, 1
    s_cbranch_scc1 L_done
    s_waitcnt lgkmcnt(0)
    v_readfirstlane_b32 s36, v20
    s_cmp_gt_u32 s36, 126
    s_cbranch_scc0 L_sp16
L_ok16:
    s_mov_b32 exec_hi, 0
    global_store_dwordx4 v10, v[72:75], s[24:25] sc1
    s_mov_b64 exec, -1
    v_add_u32 v10, 458752, v10
L_it:
    s_cmp_gt_u32 s36, s42
    s_cbranch_scc1 L_ok17
L_sp17:
    s_sleep 1
    ds_read_b32 v20, v2 offset:0
    s_sub_u32 s27, s27, 1
    s_cbranch_scc1 L_done
    s_waitcnt lgkmcnt(0)
    v_readfirstlane_b32 s36, v20
    s_cmp_gt_u32 s36, s42
    s_cbranch_scc0 L_sp17
L_ok17:
    ds_read_b64_tr_b16 v[128:129], v8 offset:0
    ds_read_b64_tr_b16 v[130:131], v9 offset:0
    ds_read_b64_tr_b16 v[132:133], v8 offset:4096
    ds_read_b64_tr_b16 v[134:135], v9 offset:4096
    s_cmp_gt_u32 s36, s43
    s_cbranch_scc1 L_ok18
L_sp18:
    ds_read_b32 v20, v2 offset:0
    s_sub_u32 s27, s27, 1
    s_cbranch_scc1 L_done
    s_waitcnt lgkmcnt(0)
    v_readfirstlane_b32 s36, v20
    s_cmp_gt_u32 s36, s43
    s_cbranch_scc0 L_sp18
L_ok18:
    ds_read_b64_tr_b16 v[136:137], v8 offset:8192
    ds_read_b64_tr_b16 v[138:139], v9 offset:8192
    ds_read_b64_tr_b16 v[140:141], v8 offset:12288
    ds_read_b64_tr_b16 v[142:143], v9 offset:12288
    s_cmp_eq_u32 s47, 3
    s_cbranch_scc1 L_itA
L_proj:
    s_mov_b64 s[56:57], -1
    s_mov_b64 s[58:59], -1
    s_mov_b64 s[60:61], -1
    s_mov_b64 s[62:63], -1
L_opoll:
    s_mov_b64 exec, s[56:57]
    global_load_dwordx4 v[24:27], v11, s[24:25] offset:0 sc1
    s_mov_b64 exec, s[58:59]
    global_load_dwordx4 v[28:31], v11, s[24:25] offset:1024 sc1
    s_mov_b64 exec, s[60:61]
    global_load_dwordx4 v[32:35], v11, s[24:25] offset:2048 sc1
    s_mov_b64 exec, s[62:63]
    global_load_dwordx4 v[36:39], v11, s[24:25] offset:3072 sc1
    s_mov_b64 exec, -1
    s_sub_u32 s27, s27, 8
    s_cbranch_scc1 L_done
L_ochk:
    s_waitcnt vmcnt(3)
    v_bitop3_b32 v20, v25, v27, s26 bitop3:0x7e
    ds_write2_b32 v100, v24, v26 offset1:1
    v_cmp_ne_u32 s[56:57], 0, v20
    s_waitcnt vmcnt(2)
    v_bitop3_b32 v20, v29, v31, s26 bitop3:0x7e
    ds_write2_b32 v101, v28, v30 offset1:1
    v_cmp_ne_u32 s[58:59], 0, v20
    s_or_b64 s[64:65], s[56:57], s[58:59]
    s_waitcnt vmcnt(1)
    v_bitop3_b32 v20, v33, v35, s26 bitop3:0x7e
    ds_write2_b32 v102, v32, v34 offset1:1
    v_cmp_ne_u32 s[60:61], 0, v20
    s_or_b64 s[64:65], s[64:65], s[60:61]
    s_waitcnt vmcnt(0)
    v_bitop3_b32 v20, v37, v39, s26 bitop3:0x7e
    ds_write2_b32 v103, v36, v38 offset1:1
    v_cmp_ne_u32 s[62:63], 0, v20
    s_or_b64 s[64:65], s[64:65], s[62:63]
    s_cbranch_scc1 L_opoll
    s_cmp_eq_u32 s47, 3
    s_cbranch_scc1 L_cntA
    s_waitcnt lgkmcnt(0)
    s_barrier
L_frag:
    ds_read_b128 v[24:27], v16 offset:0
    ds_read_b128 v[28:31], v16 offset:64
    ds_read_b128 v[32:35], v16 offset:128
    ds_read_b128 v[36:39], v16 offset:192
    ds_read_b128 v[40:43], v16 offset:4352
    ds_read_b128 v[44:47], v16 offset:4416
    ds_read_b128 v[48:51], v16 offset:4480
    ds_read_b128 v[52:55], v16 offset:4544
    s_waitcnt lgkmcnt(7)
    v_mfma_f32_16x16x32_bf16 v[56:59], v[24:27], v[128:131], 0
    s_waitcnt lgkmcnt(6)
    v_mfma_f32_16x16x32_bf16 v[56:59], v[28:31], v[132:135], v[56:59]
    s_waitcnt lgkmcnt(5)
    v_mfma_f32_16x16x32_bf16 v[56:59], v[32:35], v[136:139], v[56:59]
    s_waitcnt lgkmcnt(4)
    v_mfma_f32_16x16x32_bf16 v[56:59], v[36:39], v[140:143], v[56:59]
    s_waitcnt lgkmcnt(3)
    v_mfma_f32_16x16x32_bf16 v[56:59], v[40:43], v[128:131], v[56:59]
    s_waitcnt lgkmcnt(2)
    v_mfma_f32_16x16x32_bf16 v[56:59], v[44:47], v[132:135], v[56:59]
    s_waitcnt lgkmcnt(1)
    v_mfma_f32_16x16x32_bf16 v[56:59], v[48:51], v[136:139], v[56:59]
    s_waitcnt lgkmcnt(0)
    v_mfma_f32_16x16x32_bf16 v[56:59], v[52:55], v[140:143], v[56:59]
    s_cmp_eq_u32 s47, 3
    s_nop 6
    v_permlane32_swap_b32 v56, v60
    v_permlane32_swap_b32 v57, v61
    v_permlane32_swap_b32 v58, v62
    v_permlane32_swap_b32 v59, v63
    v_add_f32 v72, v56, v60
    v_add_f32 v73, v57, v61
    v_add_f32 v74, v58, v62
    v_add_f32 v75, v59, v63
    v_and_or_b32 v72, v72, s50, v12
    v_and_or_b32 v73, v73, s50, v12
    v_and_or_b32 v74, v74, s50, v12
    v_and_or_b32 v75, v75, s50, v12
    s_cbranch_scc1 L_itA2
    s_mov_b32 exec_hi, 0
    global_store_dwordx4 v10, v[72:75], s[24:25] sc1
    s_bitcmp1_b32 s5, 0
    s_cbranch_scc0 L_done
    s_mov_b64 exec, -1
    s_waitcnt vmcnt(0)
L_zpoll:
    global_load_dwordx4 v[24:27], v18, s[24:25] sc1
    s_sub_u32 s27, s27, 8
    s_cbranch_scc1 L_done
    s_waitcnt vmcnt(0)
    v_bitop3_b32 v20, v24, v25, s26 bitop3:0x7e
    v_bitop3_b32 v21, v26, v27, s26 bitop3:0x7e
    v_bitop3_b32 v20, v20, v21, s51 bitop3:0xa8
    v_cmp_ne_u32 vcc, 0, v20
    s_and_b64 exec, exec, vcc
    s_cbranch_execnz L_zpoll
    s_mov_b64 exec, -1
    v_xor_b32 v24, v23, v24
    v_xor_b32 v26, v23, v26
    v_xor_b32 v25, v23, v25
    v_xor_b32 v27, v23, v27
    v_permlane32_swap_b32 v24, v26
    s_nop 0
    v_permlane32_swap_b32 v25, v27
    v_add_f32 v24, v24, v26
    v_add_f32 v25, v25, v27
    s_nop 1
    v_permlane16_swap_b32 v24, v25
    v_add_f32 v24, v24, v25
    s_nop 1
    v_add_f32_dpp v24, v24, v24 row_ror:8 row_mask:0xf bank_mask:0xf
    s_nop 1
    v_add_f32_dpp v24, v24, v24 row_ror:4 row_mask:0xf bank_mask:0xf
    s_nop 1
    v_add_f32_dpp v24, v24, v24 row_ror:2 row_mask:0xf bank_mask:0xf
    s_mov_b64 exec, s[68:69]
    v_cvt_pk_bf16_f32 v24, v24, v24
    global_store_short v19, v24, s[22:23]
L_done:
    s_endpgm
.section .rodata,"a"
.p2align 6
.amdhsa_kernel concat_heads__gqa_block_cached__gqa_block_cached__decode_kernel
  .amdhsa_next_free_vgpr 256
  .amdhsa_next_free_sgpr 102
  .amdhsa_accum_offset 256
  .amdhsa_group_segment_fixed_size 0
  .amdhsa_kernarg_size 104
  .amdhsa_user_sgpr_count 2
  .amdhsa_user_sgpr_kernarg_segment_ptr 1
  .amdhsa_system_sgpr_workgroup_id_x 1
.end_amdhsa_kernel
```
